```python
import torch

def _softmax(x, axis=-1):
    return torch.softmax(x, dim=axis)
def _gelu(x):
    return torch.nn.functional.gelu(x, approximate="tanh")
def _silu(x):
    return torch.nn.functional.silu(x)
def _sigmoid(x):
    return torch.sigmoid(x)
def _layernorm(x, axis=-1, eps=1e-5):
    m = x.mean(dim=axis, keepdim=True)
    v = x.var(dim=axis, keepdim=True, unbiased=False)
    return (x - m) / torch.sqrt(v + eps)
def _scatter_add(tgt, idx, src, axis=0):
    return tgt.clone().index_add_(axis, idx, src)
def _segment_sum(src, seg, n):
    out = torch.zeros((n,) + src.shape[1:], dtype=src.dtype)
    return out.index_add_(0, seg, src)
def _pad(x, pw):
    flat = tuple(v for pair in reversed(pw) for v in pair)
    return torch.nn.functional.pad(x, flat)

kernel_name = 'gated_mix__linear_kernel_hedgehog__softmax_full_mha__prompt'

def setup_inputs():

    _w = (lambda a: (lambda t: t.to(torch.bfloat16) if t.is_floating_point() else t)(torch.as_tensor(a)))
    def _A_setup():
        B, S, D, H = 1, 2048, 512, 32
        Dh = D // H
        return {
            "x": _w((lambda *s: torch.randn(*s, dtype=torch.bfloat16) * 0.05)(B, S, D)),
            "wqkv": _w((lambda *s: torch.randn(*s, dtype=torch.bfloat16) * 3.2)(D, 3 * D)),
            "w_phi": _w((lambda *s: torch.randn(*s, dtype=torch.bfloat16) * 3.2)(H, Dh, Dh) * (Dh ** -0.5)),
            "wo": _w((lambda *s: torch.randn(*s, dtype=torch.bfloat16) * 0.05)(D, D)),
        }
    _A_in = _A_setup()

    def _B_setup():
        B, S, D = 1, 2048, 512
        return {
            "x": _w((lambda *s: torch.randn(*s, dtype=torch.bfloat16) * 0.05)(B, S, D)),
            "wqkv": _w((lambda *s: torch.randn(*s, dtype=torch.bfloat16) * 1.6)(D, 3 * D)),
            "wo": _w((lambda *s: torch.randn(*s, dtype=torch.bfloat16) * 0.05)(D, D)),
        }
    _B_in = _B_setup()

    return {
        "A_x": _A_in["x"],
        "A_wqkv": _A_in["wqkv"],
        "A_w_phi": _A_in["w_phi"],
        "A_wo": _A_in["wo"],
        "B_x": _B_in["x"],
        "B_wqkv": _B_in["wqkv"],
        "B_wo": _B_in["wo"],
        "gate_w": _w((lambda *s: torch.randn(*s, dtype=torch.bfloat16) * 0.05)(512) * 16.0),
    }

def reference(A_x, A_wqkv, A_w_phi, A_wo, B_x, B_wqkv, B_wo, gate_w):
    def _A_ref(x, wqkv, w_phi, wo):
        B, S, D = x.shape
        H = 32; Dh = D // H
        qkv = (lambda x, *d: x.permute(*d))((x @ wqkv).reshape(B, S, 3, H, Dh), 2, 0, 3, 1, 4)
        q, k, v = qkv[0], qkv[1], qkv[2]
        pq = torch.einsum("bhsd,hdf->bhsf", q, w_phi)
        pk = torch.einsum("bhsd,hdf->bhsf", k, w_phi)
        phi_q = torch.concatenate([_softmax(pq, axis=-1), _softmax(-pq, axis=-1)], axis=-1)
        phi_k = torch.concatenate([_softmax(pk, axis=-1), _softmax(-pk, axis=-1)], axis=-1)
        kv = torch.einsum("bhsf,bhsd->bhfd", phi_k, v)
        z  = torch.einsum("bhsf->bhf", phi_k)
        num = torch.einsum("bhqf,bhfd->bhqd", phi_q, kv)
        den = torch.einsum("bhqf,bhf->bhq", phi_q, z)[..., None] + 1e-6
        o = num / den
        return (lambda x, *d: x.permute(*d))(o, 0, 2, 1, 3).reshape(B, S, D) @ wo

    def _B_ref(x, wqkv, wo):
        B, S, D = x.shape
        H = 32; Dh = D // H
        qkv = (lambda x, *d: x.permute(*d))((x @ wqkv).reshape(B, S, 3, H, Dh), 2, 0, 3, 1, 4)
        q, k, v = qkv[0], qkv[1], qkv[2]
        scale = Dh ** -0.5
        scores = torch.einsum("bhqd,bhkd->bhqk", q, k) * scale
        p = _softmax(scores, axis=-1)
        o = torch.einsum("bhqk,bhkd->bhqd", p, v)
        return (lambda x, *d: x.permute(*d))(o, 0, 2, 1, 3).reshape(B, S, D) @ wo

    x = A_x
    g = _sigmoid((x * gate_w).sum(-1, keepdims=True))
    a = _A_ref(x, A_wqkv, A_w_phi, A_wo)
    b = _B_ref(x, B_wqkv, B_wo)
    return g * a + (1 - g) * b
```

```asm
; @launch grid=(256,1,1) block=(512,1,1) lds=163840
.amdgcn_target "amdgcn-amd-amdhsa--gfx950"
.text
.globl gated_mix__linear_kernel_hedgehog__softmax_full_mha__prompt_kernel
.p2align 8
.type gated_mix__linear_kernel_hedgehog__softmax_full_mha__prompt_kernel,@function
gated_mix__linear_kernel_hedgehog__softmax_full_mha__prompt_kernel:
    s_cmp_ge_u32 s2, 256
    s_cbranch_scc1 L_end
    s_load_dwordx8 s[4:11], s[0:1], 0
    s_load_dwordx8 s[12:19], s[0:1], 32
    s_load_dwordx4 s[20:23], s[0:1], 64
    s_load_dwordx2 s[24:25], s[0:1], 80
    s_and_b32 s63, s2, 7
    s_lshr_b32 s64, s2, 3
    s_and_b32 s60, s63, 3
    s_lshl_b32 s60, s60, 1
    s_and_b32 s65, s64, 1
    s_add_u32 s60, s60, s65
    s_lshr_b32 s61, s63, 2
    s_lshl_b32 s61, s61, 4
    s_lshr_b32 s65, s64, 1
    s_add_u32 s61, s61, s65
    s_lshl_b32 s3, s63, 2
    s_lshr_b32 s65, s64, 3
    s_add_u32 s3, s3, s65
    s_lshl_b32 s68, s60, 2
    s_add_u32 s68, s68, s61
    s_and_b32 s68, s68, 7
    v_and_b32 v1, 63, v0
    v_lshrrev_b32 v4, 6, v0
    v_lshlrev_b32 v2, 4, v1
    v_readfirstlane_b32 s62, v4
    v_lshlrev_b32 v16, 3, v1
    v_mov_b32 v3, 0
    s_mov_b32 s67, 0x3fb8aa3b
    s_cmp_ge_u32 s62, 4
    s_cbranch_scc1 L_loader
    v_lshrrev_b32 v4, 3, v1
    v_and_b32 v5, 7, v1
    v_lshrrev_b32 v6, 1, v4
    v_xor_b32 v7, v5, v6
    v_lshlrev_b32 v7, 4, v7
    v_lshl_add_u32 v252, v4, 10, v7
    v_xor_b32 v253, 64, v252
    s_lshl_b32 s80, s61, 16
    s_lshl_b32 s63, s62, 14
    s_add_u32 s80, s80, s63
    s_lshl_b32 s82, s62, 11
    s_waitcnt lgkmcnt(0)
    s_mov_b32 s28, s4
    s_and_b32 s29, s5, 0xffff
    s_mov_b32 s30, 2097152
    s_mov_b32 s31, 0x00020000
    s_mov_b32 s32, s14
    s_and_b32 s33, s15, 0xffff
    s_mov_b32 s34, 1572864
    s_mov_b32 s35, 0x00020000
    s_or_b32 s63, s2, s62
    s_cmp_lg_u32 s63, 0
    s_cbranch_scc1 L_nonon
    s_mov_b32 s56, s22
    s_and_b32 s57, s23, 0xffff
    s_mov_b32 s58, 256
    s_mov_b32 s59, 0x00020000
    s_memrealtime s[78:79]
    s_waitcnt lgkmcnt(0)
    s_or_b32 s79, s79, 0x80000000
    v_mov_b32 v4, s78
    v_mov_b32 v5, s79
    s_mov_b64 exec, 1
    buffer_store_dwordx2 v[4:5], v3, s[56:59], 0 offen sc1
    s_mov_b64 exec, -1
L_nonon:
    s_add_u32 s63, s68, 0
    s_and_b32 s63, s63, 7
    s_lshl_b32 s84, s63, 7
    s_add_u32 s84, s84, s80
    s_add_u32 m0, s82, 0
    s_add_u32 s72, s84, 0
    buffer_load_dwordx4 v252, s[28:31], s72 offen lds
    s_add_u32 m0, s82, 1024
    s_add_u32 s72, s84, 8192
    buffer_load_dwordx4 v253, s[28:31], s72 offen lds
    s_add_u32 s63, s68, 1
    s_and_b32 s63, s63, 7
    s_lshl_b32 s84, s63, 7
    s_add_u32 s84, s84, s80
    s_add_u32 m0, s82, 8192
    s_add_u32 s72, s84, 0
    buffer_load_dwordx4 v252, s[28:31], s72 offen lds
    s_add_u32 m0, s82, 9216
    s_add_u32 s72, s84, 8192
    buffer_load_dwordx4 v253, s[28:31], s72 offen lds
    s_add_u32 s63, s68, 2
    s_and_b32 s63, s63, 7
    s_lshl_b32 s84, s63, 7
    s_add_u32 s84, s84, s80
    s_add_u32 m0, s82, 16384
    s_add_u32 s72, s84, 0
    buffer_load_dwordx4 v252, s[28:31], s72 offen lds
    s_add_u32 m0, s82, 17408
    s_add_u32 s72, s84, 8192
    buffer_load_dwordx4 v253, s[28:31], s72 offen lds
    s_add_u32 s63, s68, 3
    s_and_b32 s63, s63, 7
    s_lshl_b32 s84, s63, 7
    s_add_u32 s84, s84, s80
    s_add_u32 m0, s82, 24576
    s_add_u32 s72, s84, 0
    buffer_load_dwordx4 v252, s[28:31], s72 offen lds
    s_add_u32 m0, s82, 25600
    s_add_u32 s72, s84, 8192
    buffer_load_dwordx4 v253, s[28:31], s72 offen lds
    s_mov_b32 s44, s6
    s_and_b32 s45, s7, 0xffff
    s_mov_b32 s46, 1572864
    s_mov_b32 s47, 0x00020000
    s_mov_b32 s36, s24
    s_and_b32 s37, s25, 0xffff
    s_mov_b32 s38, 16777216
    s_mov_b32 s39, 0x00020000
    s_mov_b32 s40, s8
    s_and_b32 s41, s9, 0xffff
    s_mov_b32 s42, 16384
    s_mov_b32 s43, 0x00020000
    s_mov_b32 s48, s18
    s_and_b32 s49, s19, 0xffff
    s_mov_b32 s50, 1024
    s_mov_b32 s51, 0x00020000
    s_mov_b32 s56, s22
    s_and_b32 s57, s23, 0xffff
    s_mov_b32 s58, 256
    s_mov_b32 s59, 0x00020000
    s_mov_b32 s52, s20
    s_and_b32 s53, s21, 0xffff
    s_mov_b32 s54, 2097152
    s_mov_b32 s55, 0x00020000
    s_and_b32 s69, s62, 1
    s_lshl_b32 s70, s61, 1
    s_add_u32 s70, s70, s69
    s_and_b32 s71, s62, 3
    s_lshl_b32 s63, s60, 2
    s_add_u32 s71, s71, s63
    s_and_b32 s63, s62, 1
    s_lshl_b32 s63, s63, 4
    s_lshl_b32 s76, 0xffff, s63
    s_mov_b32 s77, s76
    v_and_b32 v4, 31, v1
    v_lshrrev_b32 v5, 5, v1
    v_lshlrev_b32 v5, 2, v5
    v_sub_u32 v4, v4, v5
    v_mov_b32 v6, 0x3f80
    v_mov_b32 v7, 0x3f800000
    v_cmp_eq_u32 vcc, 0, v4
    s_nop 1
    v_cndmask_b32 v28, 0, v6, vcc
    v_cmp_eq_u32 vcc, 1, v4
    s_nop 1
    v_cndmask_b32 v28, v28, v7, vcc
    v_cmp_eq_u32 vcc, 2, v4
    s_nop 1
    v_cndmask_b32 v29, 0, v6, vcc
    v_cmp_eq_u32 vcc, 3, v4
    s_nop 1
    v_cndmask_b32 v29, v29, v7, vcc
    v_cmp_eq_u32 vcc, 8, v4
    s_nop 1
    v_cndmask_b32 v30, 0, v6, vcc
    v_cmp_eq_u32 vcc, 9, v4
    s_nop 1
    v_cndmask_b32 v30, v30, v7, vcc
    v_cmp_eq_u32 vcc, 10, v4
    s_nop 1
    v_cndmask_b32 v31, 0, v6, vcc
    v_cmp_eq_u32 vcc, 11, v4
    s_nop 1
    v_cndmask_b32 v31, v31, v7, vcc
    v_cmp_eq_u32 vcc, 16, v4
    s_nop 1
    v_cndmask_b32 v32, 0, v6, vcc
    v_cmp_eq_u32 vcc, 17, v4
    s_nop 1
    v_cndmask_b32 v32, v32, v7, vcc
    v_cmp_eq_u32 vcc, 18, v4
    s_nop 1
    v_cndmask_b32 v33, 0, v6, vcc
    v_cmp_eq_u32 vcc, 19, v4
    s_nop 1
    v_cndmask_b32 v33, v33, v7, vcc
    v_cmp_eq_u32 vcc, 24, v4
    s_nop 1
    v_cndmask_b32 v34, 0, v6, vcc
    v_cmp_eq_u32 vcc, 25, v4
    s_nop 1
    v_cndmask_b32 v34, v34, v7, vcc
    v_cmp_eq_u32 vcc, 26, v4
    s_nop 1
    v_cndmask_b32 v35, 0, v6, vcc
    v_cmp_eq_u32 vcc, 27, v4
    s_nop 1
    v_cndmask_b32 v35, v35, v7, vcc
    v_and_b32 v17, 15, v1
    v_lshlrev_b32 v17, 4, v17
    v_lshrrev_b32 v5, 5, v1
    v_lshl_add_u32 v17, v5, 8, v17
    v_and_b32 v4, 31, v1
    v_lshrrev_b32 v5, 5, v1
    v_bfe_u32 v6, v4, 1, 3
    v_lshlrev_b32 v7, 7, v4
    s_lshl_b32 s63, s69, 12
    v_add_u32 v7, s63, v7
    v_or_b32 v8, 0, v5
    v_xor_b32 v8, v8, v6
    v_lshl_add_u32 v76, v8, 4, v7
    v_or_b32 v8, 2, v5
    v_xor_b32 v8, v8, v6
    v_lshl_add_u32 v77, v8, 4, v7
    v_or_b32 v8, 4, v5
    v_xor_b32 v8, v8, v6
    v_lshl_add_u32 v78, v8, 4, v7
    v_or_b32 v8, 6, v5
    v_xor_b32 v8, v8, v6
    v_lshl_add_u32 v79, v8, 4, v7
    v_bfe_u32 v9, v1, 2, 2
    v_and_b32 v4, 3, v1
    v_lshlrev_b32 v4, 3, v4
    v_bfe_u32 v10, v1, 4, 1
    v_lshl_add_u32 v4, v10, 5, v4
    s_and_b32 s63, s62, 2
    s_lshl_b32 s63, s63, 5
    v_add_u32 v4, s63, v4
    v_bfe_u32 v10, v1, 3, 1
    v_lshlrev_b32 v10, 6, v10
    v_xor_b32 v4, v4, v10
    v_lshl_add_u32 v4, v9, 7, v4
    v_lshrrev_b32 v10, 5, v1
    v_lshl_add_u32 v4, v10, 10, v4
    v_add_u32 v80, 65536, v4
    v_add_u32 v81, 90112, v4
    v_add_u32 v82, 114688, v4
    v_add_u32 v83, 139264, v4
    s_waitcnt vmcnt(6)
    s_barrier
    ds_read_b128 v[84:87], v76 offset:0
    ds_read_b64_tr_b16 v[88:89], v80 offset:0
    ds_read_b64_tr_b16 v[90:91], v80 offset:512
    ds_read_b64_tr_b16 v[92:93], v80 offset:8192
    ds_read_b64_tr_b16 v[94:95], v80 offset:8704
    ds_read_b64_tr_b16 v[96:97], v80 offset:16384
    ds_read_b64_tr_b16 v[98:99], v80 offset:16896
    ds_read_b128 v[100:103], v77 offset:0
    ds_read_b64_tr_b16 v[104:105], v80 offset:2048
    ds_read_b64_tr_b16 v[106:107], v80 offset:2560
    ds_read_b64_tr_b16 v[108:109], v80 offset:10240
    ds_read_b64_tr_b16 v[110:111], v80 offset:10752
    ds_read_b64_tr_b16 v[112:113], v80 offset:18432
    ds_read_b64_tr_b16 v[114:115], v80 offset:18944
    s_waitcnt lgkmcnt(7)
    v_mfma_f32_32x32x16_bf16 v[132:147], v[88:91], v[84:87], 0
    ds_read_b128 v[116:119], v78 offset:0
    ds_read_b64_tr_b16 v[120:121], v80 offset:4096
    ds_read_b64_tr_b16 v[122:123], v80 offset:4608
    v_mfma_f32_32x32x16_bf16 v[148:163], v[92:95], v[84:87], 0
    ds_read_b64_tr_b16 v[124:125], v80 offset:12288
    ds_read_b64_tr_b16 v[126:127], v80 offset:12800
    v_mfma_f32_32x32x16_bf16 v[164:179], v[84:87], v[96:99], 0
    ds_read_b64_tr_b16 v[128:129], v80 offset:20480
    ds_read_b64_tr_b16 v[130:131], v80 offset:20992
    s_waitcnt lgkmcnt(7)
    v_mfma_f32_32x32x16_bf16 v[132:147], v[104:107], v[100:103], v[132:147]
    ds_read_b128 v[84:87], v79 offset:0
    ds_read_b64_tr_b16 v[88:89], v80 offset:6144
    ds_read_b64_tr_b16 v[90:91], v80 offset:6656
    v_mfma_f32_32x32x16_bf16 v[148:163], v[108:111], v[100:103], v[148:163]
    ds_read_b64_tr_b16 v[92:93], v80 offset:14336
    ds_read_b64_tr_b16 v[94:95], v80 offset:14848
    v_mfma_f32_32x32x16_bf16 v[164:179], v[100:103], v[112:115], v[164:179]
    ds_read_b64_tr_b16 v[96:97], v80 offset:22528
    ds_read_b64_tr_b16 v[98:99], v80 offset:23040
    s_waitcnt lgkmcnt(0) vmcnt(4)
    s_barrier
    v_mfma_f32_32x32x16_bf16 v[132:147], v[120:123], v[116:119], v[132:147]
    ds_read_b128 v[100:103], v76 offset:8192
    ds_read_b64_tr_b16 v[104:105], v81 offset:0
    ds_read_b64_tr_b16 v[106:107], v81 offset:512
    v_mfma_f32_32x32x16_bf16 v[148:163], v[124:127], v[116:119], v[148:163]
    ds_read_b64_tr_b16 v[108:109], v81 offset:8192
    ds_read_b64_tr_b16 v[110:111], v81 offset:8704
    v_mfma_f32_32x32x16_bf16 v[164:179], v[116:119], v[128:131], v[164:179]
    ds_read_b64_tr_b16 v[112:113], v81 offset:16384
    ds_read_b64_tr_b16 v[114:115], v81 offset:16896
    s_waitcnt lgkmcnt(7)
    v_mfma_f32_32x32x16_bf16 v[132:147], v[88:91], v[84:87], v[132:147]
    ds_read_b128 v[116:119], v77 offset:8192
    ds_read_b64_tr_b16 v[120:121], v81 offset:2048
    ds_read_b64_tr_b16 v[122:123], v81 offset:2560
    v_mfma_f32_32x32x16_bf16 v[148:163], v[92:95], v[84:87], v[148:163]
    ds_read_b64_tr_b16 v[124:125], v81 offset:10240
    ds_read_b64_tr_b16 v[126:127], v81 offset:10752
    v_mfma_f32_32x32x16_bf16 v[164:179], v[84:87], v[96:99], v[164:179]
    ds_read_b64_tr_b16 v[128:129], v81 offset:18432
    ds_read_b64_tr_b16 v[130:131], v81 offset:18944
    s_waitcnt lgkmcnt(7)
    v_mfma_f32_32x32x16_bf16 v[132:147], v[104:107], v[100:103], v[132:147]
    ds_read_b128 v[84:87], v78 offset:8192
    ds_read_b64_tr_b16 v[88:89], v81 offset:4096
    ds_read_b64_tr_b16 v[90:91], v81 offset:4608
    v_mfma_f32_32x32x16_bf16 v[148:163], v[108:111], v[100:103], v[148:163]
    ds_read_b64_tr_b16 v[92:93], v81 offset:12288
    ds_read_b64_tr_b16 v[94:95], v81 offset:12800
    v_mfma_f32_32x32x16_bf16 v[164:179], v[100:103], v[112:115], v[164:179]
    ds_read_b64_tr_b16 v[96:97], v81 offset:20480
    ds_read_b64_tr_b16 v[98:99], v81 offset:20992
    s_waitcnt lgkmcnt(7)
    v_mfma_f32_32x32x16_bf16 v[132:147], v[120:123], v[116:119], v[132:147]
    ds_read_b128 v[100:103], v79 offset:8192
    ds_read_b64_tr_b16 v[104:105], v81 offset:6144
    ds_read_b64_tr_b16 v[106:107], v81 offset:6656
    v_mfma_f32_32x32x16_bf16 v[148:163], v[124:127], v[116:119], v[148:163]
    ds_read_b64_tr_b16 v[108:109], v81 offset:14336
    ds_read_b64_tr_b16 v[110:111], v81 offset:14848
    v_mfma_f32_32x32x16_bf16 v[164:179], v[116:119], v[128:131], v[164:179]
    ds_read_b64_tr_b16 v[112:113], v81 offset:22528
    ds_read_b64_tr_b16 v[114:115], v81 offset:23040
    s_waitcnt lgkmcnt(0) vmcnt(2)
    s_barrier
    v_mfma_f32_32x32x16_bf16 v[132:147], v[88:91], v[84:87], v[132:147]
    ds_read_b128 v[116:119], v76 offset:16384
    ds_read_b64_tr_b16 v[120:121], v82 offset:0
    ds_read_b64_tr_b16 v[122:123], v82 offset:512
    v_mfma_f32_32x32x16_bf16 v[148:163], v[92:95], v[84:87], v[148:163]
    ds_read_b64_tr_b16 v[124:125], v82 offset:8192
    ds_read_b64_tr_b16 v[126:127], v82 offset:8704
    v_mfma_f32_32x32x16_bf16 v[164:179], v[84:87], v[96:99], v[164:179]
    ds_read_b64_tr_b16 v[128:129], v82 offset:16384
    ds_read_b64_tr_b16 v[130:131], v82 offset:16896
    s_waitcnt lgkmcnt(7)
    v_mfma_f32_32x32x16_bf16 v[132:147], v[104:107], v[100:103], v[132:147]
    ds_read_b128 v[84:87], v77 offset:16384
    ds_read_b64_tr_b16 v[88:89], v82 offset:2048
    ds_read_b64_tr_b16 v[90:91], v82 offset:2560
    v_mfma_f32_32x32x16_bf16 v[148:163], v[108:111], v[100:103], v[148:163]
    ds_read_b64_tr_b16 v[92:93], v82 offset:10240
    ds_read_b64_tr_b16 v[94:95], v82 offset:10752
    v_mfma_f32_32x32x16_bf16 v[164:179], v[100:103], v[112:115], v[164:179]
    ds_read_b64_tr_b16 v[96:97], v82 offset:18432
    ds_read_b64_tr_b16 v[98:99], v82 offset:18944
    s_waitcnt lgkmcnt(7)
    v_mfma_f32_32x32x16_bf16 v[132:147], v[120:123], v[116:119], v[132:147]
    ds_read_b128 v[100:103], v78 offset:16384
    ds_read_b64_tr_b16 v[104:105], v82 offset:4096
    ds_read_b64_tr_b16 v[106:107], v82 offset:4608
    v_mfma_f32_32x32x16_bf16 v[148:163], v[124:127], v[116:119], v[148:163]
    ds_read_b64_tr_b16 v[108:109], v82 offset:12288
    ds_read_b64_tr_b16 v[110:111], v82 offset:12800
    v_mfma_f32_32x32x16_bf16 v[164:179], v[116:119], v[128:131], v[164:179]
    ds_read_b64_tr_b16 v[112:113], v82 offset:20480
    ds_read_b64_tr_b16 v[114:115], v82 offset:20992
    s_waitcnt lgkmcnt(7)
    v_mfma_f32_32x32x16_bf16 v[132:147], v[88:91], v[84:87], v[132:147]
    ds_read_b128 v[116:119], v79 offset:16384
    ds_read_b64_tr_b16 v[120:121], v82 offset:6144
    ds_read_b64_tr_b16 v[122:123], v82 offset:6656
    v_mfma_f32_32x32x16_bf16 v[148:163], v[92:95], v[84:87], v[148:163]
    ds_read_b64_tr_b16 v[124:125], v82 offset:14336
    ds_read_b64_tr_b16 v[126:127], v82 offset:14848
    v_mfma_f32_32x32x16_bf16 v[164:179], v[84:87], v[96:99], v[164:179]
    ds_read_b64_tr_b16 v[128:129], v82 offset:22528
    ds_read_b64_tr_b16 v[130:131], v82 offset:23040
    s_waitcnt lgkmcnt(0) vmcnt(0)
    s_barrier
    v_mfma_f32_32x32x16_bf16 v[132:147], v[104:107], v[100:103], v[132:147]
    ds_read_b128 v[84:87], v76 offset:24576
    ds_read_b64_tr_b16 v[88:89], v83 offset:0
    ds_read_b64_tr_b16 v[90:91], v83 offset:512
    v_mfma_f32_32x32x16_bf16 v[148:163], v[108:111], v[100:103], v[148:163]
    ds_read_b64_tr_b16 v[92:93], v83 offset:8192
    ds_read_b64_tr_b16 v[94:95], v83 offset:8704
    v_mfma_f32_32x32x16_bf16 v[164:179], v[100:103], v[112:115], v[164:179]
    ds_read_b64_tr_b16 v[96:97], v83 offset:16384
    ds_read_b64_tr_b16 v[98:99], v83 offset:16896
    s_waitcnt lgkmcnt(7)
    v_mfma_f32_32x32x16_bf16 v[132:147], v[120:123], v[116:119], v[132:147]
    ds_read_b128 v[100:103], v77 offset:24576
    ds_read_b64_tr_b16 v[104:105], v83 offset:2048
    ds_read_b64_tr_b16 v[106:107], v83 offset:2560
    v_mfma_f32_32x32x16_bf16 v[148:163], v[124:127], v[116:119], v[148:163]
    ds_read_b64_tr_b16 v[108:109], v83 offset:10240
    ds_read_b64_tr_b16 v[110:111], v83 offset:10752
    v_mfma_f32_32x32x16_bf16 v[164:179], v[116:119], v[128:131], v[164:179]
    ds_read_b64_tr_b16 v[112:113], v83 offset:18432
    ds_read_b64_tr_b16 v[114:115], v83 offset:18944
    s_waitcnt lgkmcnt(7)
    v_mfma_f32_32x32x16_bf16 v[132:147], v[88:91], v[84:87], v[132:147]
    ds_read_b128 v[116:119], v78 offset:24576
    ds_read_b64_tr_b16 v[120:121], v83 offset:4096
    ds_read_b64_tr_b16 v[122:123], v83 offset:4608
    v_mfma_f32_32x32x16_bf16 v[148:163], v[92:95], v[84:87], v[148:163]
    ds_read_b64_tr_b16 v[124:125], v83 offset:12288
    ds_read_b64_tr_b16 v[126:127], v83 offset:12800
    v_mfma_f32_32x32x16_bf16 v[164:179], v[84:87], v[96:99], v[164:179]
    ds_read_b64_tr_b16 v[128:129], v83 offset:20480
    ds_read_b64_tr_b16 v[130:131], v83 offset:20992
    s_waitcnt lgkmcnt(7)
    v_mfma_f32_32x32x16_bf16 v[132:147], v[104:107], v[100:103], v[132:147]
    ds_read_b128 v[84:87], v79 offset:24576
    ds_read_b64_tr_b16 v[88:89], v83 offset:6144
    ds_read_b64_tr_b16 v[90:91], v83 offset:6656
    v_mfma_f32_32x32x16_bf16 v[148:163], v[108:111], v[100:103], v[148:163]
    ds_read_b64_tr_b16 v[92:93], v83 offset:14336
    ds_read_b64_tr_b16 v[94:95], v83 offset:14848
    v_mfma_f32_32x32x16_bf16 v[164:179], v[100:103], v[112:115], v[164:179]
    ds_read_b64_tr_b16 v[96:97], v83 offset:22528
    ds_read_b64_tr_b16 v[98:99], v83 offset:23040
    s_waitcnt lgkmcnt(0)
    s_barrier
    v_mfma_f32_32x32x16_bf16 v[132:147], v[120:123], v[116:119], v[132:147]
    ds_read_b128 v[100:103], v76 offset:32768
    ds_read_b64_tr_b16 v[104:105], v80 offset:0
    ds_read_b64_tr_b16 v[106:107], v80 offset:512
    v_mfma_f32_32x32x16_bf16 v[148:163], v[124:127], v[116:119], v[148:163]
    ds_read_b64_tr_b16 v[108:109], v80 offset:8192
    ds_read_b64_tr_b16 v[110:111], v80 offset:8704
    v_mfma_f32_32x32x16_bf16 v[164:179], v[116:119], v[128:131], v[164:179]
    ds_read_b64_tr_b16 v[112:113], v80 offset:16384
    ds_read_b64_tr_b16 v[114:115], v80 offset:16896
    s_waitcnt lgkmcnt(7)
    v_mfma_f32_32x32x16_bf16 v[132:147], v[88:91], v[84:87], v[132:147]
    ds_read_b128 v[116:119], v77 offset:32768
    ds_read_b64_tr_b16 v[120:121], v80 offset:2048
    ds_read_b64_tr_b16 v[122:123], v80 offset:2560
    v_mfma_f32_32x32x16_bf16 v[148:163], v[92:95], v[84:87], v[148:163]
    ds_read_b64_tr_b16 v[124:125], v80 offset:10240
    ds_read_b64_tr_b16 v[126:127], v80 offset:10752
    v_mfma_f32_32x32x16_bf16 v[164:179], v[84:87], v[96:99], v[164:179]
    ds_read_b64_tr_b16 v[128:129], v80 offset:18432
    ds_read_b64_tr_b16 v[130:131], v80 offset:18944
    s_waitcnt lgkmcnt(7)
    v_mfma_f32_32x32x16_bf16 v[132:147], v[104:107], v[100:103], v[132:147]
    ds_read_b128 v[84:87], v78 offset:32768
    ds_read_b64_tr_b16 v[88:89], v80 offset:4096
    ds_read_b64_tr_b16 v[90:91], v80 offset:4608
    v_mfma_f32_32x32x16_bf16 v[148:163], v[108:111], v[100:103], v[148:163]
    ds_read_b64_tr_b16 v[92:93], v80 offset:12288
    ds_read_b64_tr_b16 v[94:95], v80 offset:12800
    v_mfma_f32_32x32x16_bf16 v[164:179], v[100:103], v[112:115], v[164:179]
    ds_read_b64_tr_b16 v[96:97], v80 offset:20480
    ds_read_b64_tr_b16 v[98:99], v80 offset:20992
    s_waitcnt lgkmcnt(7)
    v_mfma_f32_32x32x16_bf16 v[132:147], v[120:123], v[116:119], v[132:147]
    ds_read_b128 v[100:103], v79 offset:32768
    ds_read_b64_tr_b16 v[104:105], v80 offset:6144
    ds_read_b64_tr_b16 v[106:107], v80 offset:6656
    v_mfma_f32_32x32x16_bf16 v[148:163], v[124:127], v[116:119], v[148:163]
    ds_read_b64_tr_b16 v[108:109], v80 offset:14336
    ds_read_b64_tr_b16 v[110:111], v80 offset:14848
    v_mfma_f32_32x32x16_bf16 v[164:179], v[116:119], v[128:131], v[164:179]
    ds_read_b64_tr_b16 v[112:113], v80 offset:22528
    ds_read_b64_tr_b16 v[114:115], v80 offset:23040
    s_waitcnt lgkmcnt(0)
    s_barrier
    v_mfma_f32_32x32x16_bf16 v[132:147], v[88:91], v[84:87], v[132:147]
    ds_read_b128 v[116:119], v76 offset:40960
    ds_read_b64_tr_b16 v[120:121], v81 offset:0
    ds_read_b64_tr_b16 v[122:123], v81 offset:512
    v_mfma_f32_32x32x16_bf16 v[148:163], v[92:95], v[84:87], v[148:163]
    ds_read_b64_tr_b16 v[124:125], v81 offset:8192
    ds_read_b64_tr_b16 v[126:127], v81 offset:8704
    v_mfma_f32_32x32x16_bf16 v[164:179], v[84:87], v[96:99], v[164:179]
    ds_read_b64_tr_b16 v[128:129], v81 offset:16384
    ds_read_b64_tr_b16 v[130:131], v81 offset:16896
    s_waitcnt lgkmcnt(7)
    v_mfma_f32_32x32x16_bf16 v[132:147], v[104:107], v[100:103], v[132:147]
    ds_read_b128 v[84:87], v77 offset:40960
    ds_read_b64_tr_b16 v[88:89], v81 offset:2048
    ds_read_b64_tr_b16 v[90:91], v81 offset:2560
    v_mfma_f32_32x32x16_bf16 v[148:163], v[108:111], v[100:103], v[148:163]
    ds_read_b64_tr_b16 v[92:93], v81 offset:10240
    ds_read_b64_tr_b16 v[94:95], v81 offset:10752
    v_mfma_f32_32x32x16_bf16 v[164:179], v[100:103], v[112:115], v[164:179]
    ds_read_b64_tr_b16 v[96:97], v81 offset:18432
    ds_read_b64_tr_b16 v[98:99], v81 offset:18944
    s_waitcnt lgkmcnt(7)
    v_mfma_f32_32x32x16_bf16 v[132:147], v[120:123], v[116:119], v[132:147]
    ds_read_b128 v[100:103], v78 offset:40960
    ds_read_b64_tr_b16 v[104:105], v81 offset:4096
    ds_read_b64_tr_b16 v[106:107], v81 offset:4608
    v_mfma_f32_32x32x16_bf16 v[148:163], v[124:127], v[116:119], v[148:163]
    ds_read_b64_tr_b16 v[108:109], v81 offset:12288
    ds_read_b64_tr_b16 v[110:111], v81 offset:12800
    v_mfma_f32_32x32x16_bf16 v[164:179], v[116:119], v[128:131], v[164:179]
    ds_read_b64_tr_b16 v[112:113], v81 offset:20480
    ds_read_b64_tr_b16 v[114:115], v81 offset:20992
    s_waitcnt lgkmcnt(7)
    v_mfma_f32_32x32x16_bf16 v[132:147], v[88:91], v[84:87], v[132:147]
    ds_read_b128 v[116:119], v79 offset:40960
    ds_read_b64_tr_b16 v[120:121], v81 offset:6144
    ds_read_b64_tr_b16 v[122:123], v81 offset:6656
    v_mfma_f32_32x32x16_bf16 v[148:163], v[92:95], v[84:87], v[148:163]
    ds_read_b64_tr_b16 v[124:125], v81 offset:14336
    ds_read_b64_tr_b16 v[126:127], v81 offset:14848
    v_mfma_f32_32x32x16_bf16 v[164:179], v[84:87], v[96:99], v[164:179]
    ds_read_b64_tr_b16 v[128:129], v81 offset:22528
    ds_read_b64_tr_b16 v[130:131], v81 offset:23040
    s_waitcnt lgkmcnt(0)
    s_barrier
    v_mfma_f32_32x32x16_bf16 v[132:147], v[104:107], v[100:103], v[132:147]
    ds_read_b128 v[84:87], v76 offset:49152
    ds_read_b64_tr_b16 v[88:89], v82 offset:0
    ds_read_b64_tr_b16 v[90:91], v82 offset:512
    v_mfma_f32_32x32x16_bf16 v[148:163], v[108:111], v[100:103], v[148:163]
    ds_read_b64_tr_b16 v[92:93], v82 offset:8192
    ds_read_b64_tr_b16 v[94:95], v82 offset:8704
    v_mfma_f32_32x32x16_bf16 v[164:179], v[100:103], v[112:115], v[164:179]
    ds_read_b64_tr_b16 v[96:97], v82 offset:16384
    ds_read_b64_tr_b16 v[98:99], v82 offset:16896
    s_waitcnt lgkmcnt(7)
    v_mfma_f32_32x32x16_bf16 v[132:147], v[120:123], v[116:119], v[132:147]
    ds_read_b128 v[100:103], v77 offset:49152
    ds_read_b64_tr_b16 v[104:105], v82 offset:2048
    ds_read_b64_tr_b16 v[106:107], v82 offset:2560
    v_mfma_f32_32x32x16_bf16 v[148:163], v[124:127], v[116:119], v[148:163]
    ds_read_b64_tr_b16 v[108:109], v82 offset:10240
    ds_read_b64_tr_b16 v[110:111], v82 offset:10752
    v_mfma_f32_32x32x16_bf16 v[164:179], v[116:119], v[128:131], v[164:179]
    ds_read_b64_tr_b16 v[112:113], v82 offset:18432
    ds_read_b64_tr_b16 v[114:115], v82 offset:18944
    s_waitcnt lgkmcnt(7)
    v_mfma_f32_32x32x16_bf16 v[132:147], v[88:91], v[84:87], v[132:147]
    ds_read_b128 v[116:119], v78 offset:49152
    ds_read_b64_tr_b16 v[120:121], v82 offset:4096
    ds_read_b64_tr_b16 v[122:123], v82 offset:4608
    v_mfma_f32_32x32x16_bf16 v[148:163], v[92:95], v[84:87], v[148:163]
    ds_read_b64_tr_b16 v[124:125], v82 offset:12288
    ds_read_b64_tr_b16 v[126:127], v82 offset:12800
    v_mfma_f32_32x32x16_bf16 v[164:179], v[84:87], v[96:99], v[164:179]
    ds_read_b64_tr_b16 v[128:129], v82 offset:20480
    ds_read_b64_tr_b16 v[130:131], v82 offset:20992
    s_waitcnt lgkmcnt(7)
    v_mfma_f32_32x32x16_bf16 v[132:147], v[104:107], v[100:103], v[132:147]
    ds_read_b128 v[84:87], v79 offset:49152
    ds_read_b64_tr_b16 v[88:89], v82 offset:6144
    ds_read_b64_tr_b16 v[90:91], v82 offset:6656
    v_mfma_f32_32x32x16_bf16 v[148:163], v[108:111], v[100:103], v[148:163]
    ds_read_b64_tr_b16 v[92:93], v82 offset:14336
    ds_read_b64_tr_b16 v[94:95], v82 offset:14848
    v_mfma_f32_32x32x16_bf16 v[164:179], v[100:103], v[112:115], v[164:179]
    ds_read_b64_tr_b16 v[96:97], v82 offset:22528
    ds_read_b64_tr_b16 v[98:99], v82 offset:23040
    s_waitcnt lgkmcnt(0)
    s_barrier
    v_mfma_f32_32x32x16_bf16 v[132:147], v[120:123], v[116:119], v[132:147]
    ds_read_b128 v[100:103], v76 offset:57344
    ds_read_b64_tr_b16 v[104:105], v83 offset:0
    ds_read_b64_tr_b16 v[106:107], v83 offset:512
    v_mfma_f32_32x32x16_bf16 v[148:163], v[124:127], v[116:119], v[148:163]
    ds_read_b64_tr_b16 v[108:109], v83 offset:8192
    ds_read_b64_tr_b16 v[110:111], v83 offset:8704
    v_mfma_f32_32x32x16_bf16 v[164:179], v[116:119], v[128:131], v[164:179]
    ds_read_b64_tr_b16 v[112:113], v83 offset:16384
    ds_read_b64_tr_b16 v[114:115], v83 offset:16896
    s_waitcnt lgkmcnt(7)
    v_mfma_f32_32x32x16_bf16 v[132:147], v[88:91], v[84:87], v[132:147]
    ds_read_b128 v[116:119], v77 offset:57344
    ds_read_b64_tr_b16 v[120:121], v83 offset:2048
    ds_read_b64_tr_b16 v[122:123], v83 offset:2560
    v_mfma_f32_32x32x16_bf16 v[148:163], v[92:95], v[84:87], v[148:163]
    ds_read_b64_tr_b16 v[124:125], v83 offset:10240
    ds_read_b64_tr_b16 v[126:127], v83 offset:10752
    v_mfma_f32_32x32x16_bf16 v[164:179], v[84:87], v[96:99], v[164:179]
    ds_read_b64_tr_b16 v[128:129], v83 offset:18432
    ds_read_b64_tr_b16 v[130:131], v83 offset:18944
    s_waitcnt lgkmcnt(7)
    v_mfma_f32_32x32x16_bf16 v[132:147], v[104:107], v[100:103], v[132:147]
    ds_read_b128 v[84:87], v78 offset:57344
    ds_read_b64_tr_b16 v[88:89], v83 offset:4096
    ds_read_b64_tr_b16 v[90:91], v83 offset:4608
    v_mfma_f32_32x32x16_bf16 v[148:163], v[108:111], v[100:103], v[148:163]
    ds_read_b64_tr_b16 v[92:93], v83 offset:12288
    ds_read_b64_tr_b16 v[94:95], v83 offset:12800
    v_mfma_f32_32x32x16_bf16 v[164:179], v[100:103], v[112:115], v[164:179]
    ds_read_b64_tr_b16 v[96:97], v83 offset:20480
    ds_read_b64_tr_b16 v[98:99], v83 offset:20992
    s_waitcnt lgkmcnt(7)
    v_mfma_f32_32x32x16_bf16 v[132:147], v[120:123], v[116:119], v[132:147]
    ds_read_b128 v[100:103], v79 offset:57344
    ds_read_b64_tr_b16 v[104:105], v83 offset:6144
    ds_read_b64_tr_b16 v[106:107], v83 offset:6656
    v_mfma_f32_32x32x16_bf16 v[148:163], v[124:127], v[116:119], v[148:163]
    ds_read_b64_tr_b16 v[108:109], v83 offset:14336
    ds_read_b64_tr_b16 v[110:111], v83 offset:14848
    v_mfma_f32_32x32x16_bf16 v[164:179], v[116:119], v[128:131], v[164:179]
    ds_read_b64_tr_b16 v[112:113], v83 offset:22528
    ds_read_b64_tr_b16 v[114:115], v83 offset:23040
    s_waitcnt lgkmcnt(0)
    s_barrier
    v_mfma_f32_32x32x16_bf16 v[132:147], v[88:91], v[84:87], v[132:147]
    ds_read_b128 v[116:119], v76 offset:0
    ds_read_b64_tr_b16 v[120:121], v80 offset:0
    ds_read_b64_tr_b16 v[122:123], v80 offset:512
    v_mfma_f32_32x32x16_bf16 v[148:163], v[92:95], v[84:87], v[148:163]
    ds_read_b64_tr_b16 v[124:125], v80 offset:8192
    ds_read_b64_tr_b16 v[126:127], v80 offset:8704
    v_mfma_f32_32x32x16_bf16 v[164:179], v[84:87], v[96:99], v[164:179]
    ds_read_b64_tr_b16 v[128:129], v80 offset:16384
    ds_read_b64_tr_b16 v[130:131], v80 offset:16896
    s_waitcnt lgkmcnt(7)
    v_mfma_f32_32x32x16_bf16 v[132:147], v[104:107], v[100:103], v[132:147]
    ds_read_b128 v[84:87], v77 offset:0
    ds_read_b64_tr_b16 v[88:89], v80 offset:2048
    ds_read_b64_tr_b16 v[90:91], v80 offset:2560
    v_mfma_f32_32x32x16_bf16 v[148:163], v[108:111], v[100:103], v[148:163]
    ds_read_b64_tr_b16 v[92:93], v80 offset:10240
    ds_read_b64_tr_b16 v[94:95], v80 offset:10752
    v_mfma_f32_32x32x16_bf16 v[164:179], v[100:103], v[112:115], v[164:179]
    ds_read_b64_tr_b16 v[96:97], v80 offset:18432
    ds_read_b64_tr_b16 v[98:99], v80 offset:18944
    s_waitcnt lgkmcnt(7)
    v_mfma_f32_32x32x16_bf16 v[180:195], v[120:123], v[116:119], 0
    ds_read_b128 v[100:103], v78 offset:0
    ds_read_b64_tr_b16 v[104:105], v80 offset:4096
    ds_read_b64_tr_b16 v[106:107], v80 offset:4608
    v_mfma_f32_32x32x16_bf16 v[196:211], v[124:127], v[116:119], 0
    ds_read_b64_tr_b16 v[108:109], v80 offset:12288
    ds_read_b64_tr_b16 v[110:111], v80 offset:12800
    v_mfma_f32_32x32x16_bf16 v[212:227], v[116:119], v[128:131], 0
    ds_read_b64_tr_b16 v[112:113], v80 offset:20480
    ds_read_b64_tr_b16 v[114:115], v80 offset:20992
    s_waitcnt lgkmcnt(7)
    v_mfma_f32_32x32x16_bf16 v[180:195], v[88:91], v[84:87], v[180:195]
    ds_read_b128 v[116:119], v79 offset:0
    ds_read_b64_tr_b16 v[120:121], v80 offset:6144
    ds_read_b64_tr_b16 v[122:123], v80 offset:6656
    v_mul_f32 v132, 0x3eb8aa3b, v132
    v_mfma_f32_32x32x16_bf16 v[196:211], v[92:95], v[84:87], v[196:211]
    ds_read_b64_tr_b16 v[124:125], v80 offset:14336
    ds_read_b64_tr_b16 v[126:127], v80 offset:14848
    v_mul_f32 v133, 0x3eb8aa3b, v133
    v_mfma_f32_32x32x16_bf16 v[212:227], v[84:87], v[96:99], v[212:227]
    ds_read_b64_tr_b16 v[128:129], v80 offset:22528
    ds_read_b64_tr_b16 v[130:131], v80 offset:23040
    v_mul_f32 v134, 0x3eb8aa3b, v134
    s_waitcnt lgkmcnt(0)
    s_barrier
    v_mfma_f32_32x32x16_bf16 v[180:195], v[104:107], v[100:103], v[180:195]
    ds_read_b128 v[84:87], v76 offset:8192
    ds_read_b64_tr_b16 v[88:89], v81 offset:0
    ds_read_b64_tr_b16 v[90:91], v81 offset:512
    v_mul_f32 v135, 0x3eb8aa3b, v135
    v_mfma_f32_32x32x16_bf16 v[196:211], v[108:111], v[100:103], v[196:211]
    ds_read_b64_tr_b16 v[92:93], v81 offset:8192
    ds_read_b64_tr_b16 v[94:95], v81 offset:8704
    v_mul_f32 v136, 0x3eb8aa3b, v136
    v_mfma_f32_32x32x16_bf16 v[212:227], v[100:103], v[112:115], v[212:227]
    ds_read_b64_tr_b16 v[96:97], v81 offset:16384
    ds_read_b64_tr_b16 v[98:99], v81 offset:16896
    v_mul_f32 v137, 0x3eb8aa3b, v137
    s_waitcnt lgkmcnt(7)
    v_mfma_f32_32x32x16_bf16 v[180:195], v[120:123], v[116:119], v[180:195]
    ds_read_b128 v[100:103], v77 offset:8192
    ds_read_b64_tr_b16 v[104:105], v81 offset:2048
    ds_read_b64_tr_b16 v[106:107], v81 offset:2560
    v_mul_f32 v138, 0x3eb8aa3b, v138
    v_mfma_f32_32x32x16_bf16 v[196:211], v[124:127], v[116:119], v[196:211]
    ds_read_b64_tr_b16 v[108:109], v81 offset:10240
    ds_read_b64_tr_b16 v[110:111], v81 offset:10752
    v_mul_f32 v139, 0x3eb8aa3b, v139
    v_mfma_f32_32x32x16_bf16 v[212:227], v[116:119], v[128:131], v[212:227]
    ds_read_b64_tr_b16 v[112:113], v81 offset:18432
    ds_read_b64_tr_b16 v[114:115], v81 offset:18944
    v_mul_f32 v140, 0x3eb8aa3b, v140
    s_waitcnt lgkmcnt(7)
    v_mfma_f32_32x32x16_bf16 v[180:195], v[88:91], v[84:87], v[180:195]
    ds_read_b128 v[116:119], v78 offset:8192
    ds_read_b64_tr_b16 v[120:121], v81 offset:4096
    ds_read_b64_tr_b16 v[122:123], v81 offset:4608
    v_mul_f32 v141, 0x3eb8aa3b, v141
    v_mfma_f32_32x32x16_bf16 v[196:211], v[92:95], v[84:87], v[196:211]
    ds_read_b64_tr_b16 v[124:125], v81 offset:12288
    ds_read_b64_tr_b16 v[126:127], v81 offset:12800
    v_mul_f32 v142, 0x3eb8aa3b, v142
    v_mfma_f32_32x32x16_bf16 v[212:227], v[84:87], v[96:99], v[212:227]
    ds_read_b64_tr_b16 v[128:129], v81 offset:20480
    ds_read_b64_tr_b16 v[130:131], v81 offset:20992
    v_mul_f32 v143, 0x3eb8aa3b, v143
    s_waitcnt lgkmcnt(7)
    v_mfma_f32_32x32x16_bf16 v[180:195], v[104:107], v[100:103], v[180:195]
    ds_read_b128 v[84:87], v79 offset:8192
    ds_read_b64_tr_b16 v[88:89], v81 offset:6144
    ds_read_b64_tr_b16 v[90:91], v81 offset:6656
    v_mul_f32 v144, 0x3eb8aa3b, v144
    v_mfma_f32_32x32x16_bf16 v[196:211], v[108:111], v[100:103], v[196:211]
    ds_read_b64_tr_b16 v[92:93], v81 offset:14336
    ds_read_b64_tr_b16 v[94:95], v81 offset:14848
    v_mul_f32 v145, 0x3eb8aa3b, v145
    v_mfma_f32_32x32x16_bf16 v[212:227], v[100:103], v[112:115], v[212:227]
    ds_read_b64_tr_b16 v[96:97], v81 offset:22528
    ds_read_b64_tr_b16 v[98:99], v81 offset:23040
    v_mul_f32 v146, 0x3eb8aa3b, v146
    s_waitcnt lgkmcnt(0)
    s_barrier
    v_mfma_f32_32x32x16_bf16 v[180:195], v[120:123], v[116:119], v[180:195]
    ds_read_b128 v[100:103], v76 offset:16384
    ds_read_b64_tr_b16 v[104:105], v82 offset:0
    ds_read_b64_tr_b16 v[106:107], v82 offset:512
    v_mul_f32 v147, 0x3eb8aa3b, v147
    v_mfma_f32_32x32x16_bf16 v[196:211], v[124:127], v[116:119], v[196:211]
    ds_read_b64_tr_b16 v[108:109], v82 offset:8192
    ds_read_b64_tr_b16 v[110:111], v82 offset:8704
    v_cvt_pk_bf16_f32 v228, v132, v133
    v_mfma_f32_32x32x16_bf16 v[212:227], v[116:119], v[128:131], v[212:227]
    ds_read_b64_tr_b16 v[112:113], v82 offset:16384
    ds_read_b64_tr_b16 v[114:115], v82 offset:16896
    v_cvt_pk_bf16_f32 v229, v134, v135
    s_waitcnt lgkmcnt(7)
    v_mfma_f32_32x32x16_bf16 v[180:195], v[88:91], v[84:87], v[180:195]
    ds_read_b128 v[116:119], v77 offset:16384
    ds_read_b64_tr_b16 v[120:121], v82 offset:2048
    ds_read_b64_tr_b16 v[122:123], v82 offset:2560
    v_cvt_pk_bf16_f32 v230, v136, v137
    v_mfma_f32_32x32x16_bf16 v[196:211], v[92:95], v[84:87], v[196:211]
    ds_read_b64_tr_b16 v[124:125], v82 offset:10240
    ds_read_b64_tr_b16 v[126:127], v82 offset:10752
    v_cvt_pk_bf16_f32 v231, v138, v139
    v_mfma_f32_32x32x16_bf16 v[212:227], v[84:87], v[96:99], v[212:227]
    ds_read_b64_tr_b16 v[128:129], v82 offset:18432
    ds_read_b64_tr_b16 v[130:131], v82 offset:18944
    v_cvt_pk_bf16_f32 v232, v140, v141
    s_waitcnt lgkmcnt(7)
    v_mfma_f32_32x32x16_bf16 v[180:195], v[104:107], v[100:103], v[180:195]
    ds_read_b128 v[84:87], v78 offset:16384
    ds_read_b64_tr_b16 v[88:89], v82 offset:4096
    ds_read_b64_tr_b16 v[90:91], v82 offset:4608
    v_cvt_pk_bf16_f32 v233, v142, v143
    v_mfma_f32_32x32x16_bf16 v[196:211], v[108:111], v[100:103], v[196:211]
    ds_read_b64_tr_b16 v[92:93], v82 offset:12288
    ds_read_b64_tr_b16 v[94:95], v82 offset:12800
    v_cvt_pk_bf16_f32 v234, v144, v145
    v_mfma_f32_32x32x16_bf16 v[212:227], v[100:103], v[112:115], v[212:227]
    ds_read_b64_tr_b16 v[96:97], v82 offset:20480
    ds_read_b64_tr_b16 v[98:99], v82 offset:20992
    v_cvt_pk_bf16_f32 v235, v146, v147
    s_waitcnt lgkmcnt(7)
    v_mfma_f32_32x32x16_bf16 v[180:195], v[120:123], v[116:119], v[180:195]
    ds_read_b128 v[100:103], v79 offset:16384
    ds_read_b64_tr_b16 v[104:105], v82 offset:6144
    ds_read_b64_tr_b16 v[106:107], v82 offset:6656
    v_cvt_pk_bf16_f32 v236, v148, v149
    v_mfma_f32_32x32x16_bf16 v[196:211], v[124:127], v[116:119], v[196:211]
    ds_read_b64_tr_b16 v[108:109], v82 offset:14336
    ds_read_b64_tr_b16 v[110:111], v82 offset:14848
    v_cvt_pk_bf16_f32 v237, v150, v151
    v_mfma_f32_32x32x16_bf16 v[212:227], v[116:119], v[128:131], v[212:227]
    ds_read_b64_tr_b16 v[112:113], v82 offset:22528
    ds_read_b64_tr_b16 v[114:115], v82 offset:23040
    v_cvt_pk_bf16_f32 v238, v152, v153
    s_waitcnt lgkmcnt(0)
    s_barrier
    v_mfma_f32_32x32x16_bf16 v[180:195], v[88:91], v[84:87], v[180:195]
    ds_read_b128 v[116:119], v76 offset:24576
    ds_read_b64_tr_b16 v[120:121], v83 offset:0
    ds_read_b64_tr_b16 v[122:123], v83 offset:512
    v_cvt_pk_bf16_f32 v239, v154, v155
    v_mfma_f32_32x32x16_bf16 v[196:211], v[92:95], v[84:87], v[196:211]
    ds_read_b64_tr_b16 v[124:125], v83 offset:8192
    ds_read_b64_tr_b16 v[126:127], v83 offset:8704
    v_cvt_pk_bf16_f32 v240, v156, v157
    v_mfma_f32_32x32x16_bf16 v[212:227], v[84:87], v[96:99], v[212:227]
    ds_read_b64_tr_b16 v[128:129], v83 offset:16384
    ds_read_b64_tr_b16 v[130:131], v83 offset:16896
    v_cvt_pk_bf16_f32 v241, v158, v159
    s_waitcnt lgkmcnt(7)
    v_mfma_f32_32x32x16_bf16 v[180:195], v[104:107], v[100:103], v[180:195]
    ds_read_b128 v[84:87], v77 offset:24576
    ds_read_b64_tr_b16 v[88:89], v83 offset:2048
    ds_read_b64_tr_b16 v[90:91], v83 offset:2560
    v_cvt_pk_bf16_f32 v242, v160, v161
    v_mfma_f32_32x32x16_bf16 v[196:211], v[108:111], v[100:103], v[196:211]
    ds_read_b64_tr_b16 v[92:93], v83 offset:10240
    ds_read_b64_tr_b16 v[94:95], v83 offset:10752
    v_cvt_pk_bf16_f32 v243, v162, v163
    v_mfma_f32_32x32x16_bf16 v[212:227], v[100:103], v[112:115], v[212:227]
    ds_read_b64_tr_b16 v[96:97], v83 offset:18432
    ds_read_b64_tr_b16 v[98:99], v83 offset:18944
    v_cvt_pk_bf16_f32 v244, v164, v165
    s_waitcnt lgkmcnt(7)
    v_mfma_f32_32x32x16_bf16 v[180:195], v[120:123], v[116:119], v[180:195]
    ds_read_b128 v[100:103], v78 offset:24576
    ds_read_b64_tr_b16 v[104:105], v83 offset:4096
    ds_read_b64_tr_b16 v[106:107], v83 offset:4608
    v_cvt_pk_bf16_f32 v245, v166, v167
    v_mfma_f32_32x32x16_bf16 v[196:211], v[124:127], v[116:119], v[196:211]
    ds_read_b64_tr_b16 v[108:109], v83 offset:12288
    ds_read_b64_tr_b16 v[110:111], v83 offset:12800
    v_cvt_pk_bf16_f32 v246, v168, v169
    v_mfma_f32_32x32x16_bf16 v[212:227], v[116:119], v[128:131], v[212:227]
    ds_read_b64_tr_b16 v[112:113], v83 offset:20480
    ds_read_b64_tr_b16 v[114:115], v83 offset:20992
    v_cvt_pk_bf16_f32 v247, v170, v171
    s_waitcnt lgkmcnt(7)
    v_mfma_f32_32x32x16_bf16 v[180:195], v[88:91], v[84:87], v[180:195]
    ds_read_b128 v[116:119], v79 offset:24576
    ds_read_b64_tr_b16 v[120:121], v83 offset:6144
    ds_read_b64_tr_b16 v[122:123], v83 offset:6656
    v_cvt_pk_bf16_f32 v248, v172, v173
    v_mfma_f32_32x32x16_bf16 v[196:211], v[92:95], v[84:87], v[196:211]
    ds_read_b64_tr_b16 v[124:125], v83 offset:14336
    ds_read_b64_tr_b16 v[126:127], v83 offset:14848
    v_cvt_pk_bf16_f32 v249, v174, v175
    v_mfma_f32_32x32x16_bf16 v[212:227], v[84:87], v[96:99], v[212:227]
    ds_read_b64_tr_b16 v[128:129], v83 offset:22528
    ds_read_b64_tr_b16 v[130:131], v83 offset:23040
    v_cvt_pk_bf16_f32 v250, v176, v177
    s_waitcnt lgkmcnt(0)
    s_barrier
    v_mfma_f32_32x32x16_bf16 v[180:195], v[104:107], v[100:103], v[180:195]
    ds_read_b128 v[84:87], v76 offset:32768
    ds_read_b64_tr_b16 v[88:89], v80 offset:0
    ds_read_b64_tr_b16 v[90:91], v80 offset:512
    v_cvt_pk_bf16_f32 v251, v178, v179
    v_mfma_f32_32x32x16_bf16 v[196:211], v[108:111], v[100:103], v[196:211]
    ds_read_b64_tr_b16 v[92:93], v80 offset:8192
    ds_read_b64_tr_b16 v[94:95], v80 offset:8704
    s_lshl_b32 s63, s60, 2
    s_and_b32 s64, s62, 2
    v_mfma_f32_32x32x16_bf16 v[212:227], v[100:103], v[112:115], v[212:227]
    ds_read_b64_tr_b16 v[96:97], v80 offset:16384
    ds_read_b64_tr_b16 v[98:99], v80 offset:16896
    s_add_u32 s63, s63, s64
    s_lshl_b32 s63, s63, 6
    s_waitcnt lgkmcnt(7)
    v_mfma_f32_32x32x16_bf16 v[180:195], v[120:123], v[116:119], v[180:195]
    ds_read_b128 v[100:103], v77 offset:32768
    ds_read_b64_tr_b16 v[104:105], v80 offset:2048
    ds_read_b64_tr_b16 v[106:107], v80 offset:2560
    s_add_u32 s63, s63, s70
    s_lshl_b32 s63, s63, 10
    v_mfma_f32_32x32x16_bf16 v[196:211], v[124:127], v[116:119], v[196:211]
    ds_read_b64_tr_b16 v[108:109], v80 offset:10240
    ds_read_b64_tr_b16 v[110:111], v80 offset:10752
    s_add_u32 s65, s63, 65536
    buffer_store_dwordx4 v[236:239], v2, s[36:39], s63 offen sc1
    v_mfma_f32_32x32x16_bf16 v[212:227], v[116:119], v[128:131], v[212:227]
    ds_read_b64_tr_b16 v[112:113], v80 offset:18432
    ds_read_b64_tr_b16 v[114:115], v80 offset:18944
    buffer_store_dwordx4 v[240:243], v2, s[36:39], s65 offen sc1
    v_bfe_u32 v252, v1, 4, 1
    s_waitcnt lgkmcnt(7)
    v_mfma_f32_32x32x16_bf16 v[180:195], v[88:91], v[84:87], v[180:195]
    ds_read_b128 v[116:119], v78 offset:32768
    ds_read_b64_tr_b16 v[120:121], v80 offset:4096
    ds_read_b64_tr_b16 v[122:123], v80 offset:4608
    v_lshl_add_u32 v252, v252, 16, v17
    s_add_u32 s65, s63, 2097152
    v_mfma_f32_32x32x16_bf16 v[196:211], v[92:95], v[84:87], v[196:211]
    ds_read_b64_tr_b16 v[124:125], v80 offset:12288
    ds_read_b64_tr_b16 v[126:127], v80 offset:12800
    buffer_store_dwordx4 v[244:247], v252, s[36:39], s65 offen sc1
    buffer_store_dwordx4 v[248:251], v252, s[36:39], s65 offen offset:512 sc1
    v_mfma_f32_32x32x16_bf16 v[212:227], v[84:87], v[96:99], v[212:227]
    ds_read_b64_tr_b16 v[128:129], v80 offset:20480
    ds_read_b64_tr_b16 v[130:131], v80 offset:20992
    s_lshl_b32 s63, s60, 14
    s_lshl_b32 s64, s61, 9
    s_waitcnt lgkmcnt(7)
    v_mfma_f32_32x32x16_bf16 v[180:195], v[104:107], v[100:103], v[180:195]
    ds_read_b128 v[84:87], v79 offset:32768
    ds_read_b64_tr_b16 v[88:89], v80 offset:6144
    ds_read_b64_tr_b16 v[90:91], v80 offset:6656
    s_add_u32 s63, s63, s64
    s_lshl_b32 s64, s62, 7
    v_mfma_f32_32x32x16_bf16 v[196:211], v[108:111], v[100:103], v[196:211]
    ds_read_b64_tr_b16 v[92:93], v80 offset:14336
    ds_read_b64_tr_b16 v[94:95], v80 offset:14848
    s_add_u32 s63, s63, s64
    s_add_u32 s63, s63, 9437184
    v_mfma_f32_32x32x16_bf16 v[212:227], v[100:103], v[112:115], v[212:227]
    ds_read_b64_tr_b16 v[96:97], v80 offset:22528
    ds_read_b64_tr_b16 v[98:99], v80 offset:23040
    v_lshrrev_b32 v252, 5, v1
    v_lshlrev_b32 v252, 28, v252
    s_waitcnt lgkmcnt(0)
    s_barrier
    v_mfma_f32_32x32x16_bf16 v[180:195], v[120:123], v[116:119], v[180:195]
    ds_read_b128 v[100:103], v76 offset:40960
    ds_read_b64_tr_b16 v[104:105], v81 offset:0
    ds_read_b64_tr_b16 v[106:107], v81 offset:512
    v_lshl_add_u32 v252, v1, 2, v252
    buffer_store_dword v3, v252, s[36:39], s63 offen sc1
    v_mfma_f32_32x32x16_bf16 v[196:211], v[124:127], v[116:119], v[196:211]
    ds_read_b64_tr_b16 v[108:109], v81 offset:8192
    ds_read_b64_tr_b16 v[110:111], v81 offset:8704
    s_lshl_b32 s63, s62, 10
    buffer_load_dwordx2 v[12:13], v3, s[56:59], s63 offen sc1
    v_mfma_f32_32x32x16_bf16 v[212:227], v[116:119], v[128:131], v[212:227]
    ds_read_b64_tr_b16 v[112:113], v81 offset:16384
    ds_read_b64_tr_b16 v[114:115], v81 offset:16896
    s_waitcnt lgkmcnt(7)
    v_mfma_f32_32x32x16_bf16 v[180:195], v[88:91], v[84:87], v[180:195]
    ds_read_b128 v[116:119], v77 offset:40960
    ds_read_b64_tr_b16 v[120:121], v81 offset:2048
    ds_read_b64_tr_b16 v[122:123], v81 offset:2560
    v_mfma_f32_32x32x16_bf16 v[196:211], v[92:95], v[84:87], v[196:211]
    ds_read_b64_tr_b16 v[124:125], v81 offset:10240
    ds_read_b64_tr_b16 v[126:127], v81 offset:10752
    v_mfma_f32_32x32x16_bf16 v[212:227], v[84:87], v[96:99], v[212:227]
    ds_read_b64_tr_b16 v[128:129], v81 offset:18432
    ds_read_b64_tr_b16 v[130:131], v81 offset:18944
    s_waitcnt lgkmcnt(7)
    v_mfma_f32_32x32x16_bf16 v[180:195], v[104:107], v[100:103], v[180:195]
    ds_read_b128 v[84:87], v78 offset:40960
    ds_read_b64_tr_b16 v[88:89], v81 offset:4096
    ds_read_b64_tr_b16 v[90:91], v81 offset:4608
    v_mfma_f32_32x32x16_bf16 v[196:211], v[108:111], v[100:103], v[196:211]
    ds_read_b64_tr_b16 v[92:93], v81 offset:12288
    ds_read_b64_tr_b16 v[94:95], v81 offset:12800
    v_mfma_f32_32x32x16_bf16 v[212:227], v[100:103], v[112:115], v[212:227]
    ds_read_b64_tr_b16 v[96:97], v81 offset:20480
    ds_read_b64_tr_b16 v[98:99], v81 offset:20992
    s_waitcnt lgkmcnt(7)
    v_mfma_f32_32x32x16_bf16 v[180:195], v[120:123], v[116:119], v[180:195]
    ds_read_b128 v[100:103], v79 offset:40960
    ds_read_b64_tr_b16 v[104:105], v81 offset:6144
    ds_read_b64_tr_b16 v[106:107], v81 offset:6656
    v_mfma_f32_32x32x16_bf16 v[196:211], v[124:127], v[116:119], v[196:211]
    ds_read_b64_tr_b16 v[108:109], v81 offset:14336
    ds_read_b64_tr_b16 v[110:111], v81 offset:14848
    v_mfma_f32_32x32x16_bf16 v[212:227], v[116:119], v[128:131], v[212:227]
    ds_read_b64_tr_b16 v[112:113], v81 offset:22528
    ds_read_b64_tr_b16 v[114:115], v81 offset:23040
    s_waitcnt lgkmcnt(0)
    s_barrier
    v_mfma_f32_32x32x16_bf16 v[180:195], v[88:91], v[84:87], v[180:195]
    ds_read_b128 v[116:119], v76 offset:49152
    ds_read_b64_tr_b16 v[120:121], v82 offset:0
    ds_read_b64_tr_b16 v[122:123], v82 offset:512
    v_mfma_f32_32x32x16_bf16 v[196:211], v[92:95], v[84:87], v[196:211]
    ds_read_b64_tr_b16 v[124:125], v82 offset:8192
    ds_read_b64_tr_b16 v[126:127], v82 offset:8704
    v_mfma_f32_32x32x16_bf16 v[212:227], v[84:87], v[96:99], v[212:227]
    ds_read_b64_tr_b16 v[128:129], v82 offset:16384
    ds_read_b64_tr_b16 v[130:131], v82 offset:16896
    s_waitcnt lgkmcnt(7)
    v_mfma_f32_32x32x16_bf16 v[180:195], v[104:107], v[100:103], v[180:195]
    ds_read_b128 v[84:87], v77 offset:49152
    ds_read_b64_tr_b16 v[88:89], v82 offset:2048
    ds_read_b64_tr_b16 v[90:91], v82 offset:2560
    v_mfma_f32_32x32x16_bf16 v[196:211], v[108:111], v[100:103], v[196:211]
    ds_read_b64_tr_b16 v[92:93], v82 offset:10240
    ds_read_b64_tr_b16 v[94:95], v82 offset:10752
    v_mfma_f32_32x32x16_bf16 v[212:227], v[100:103], v[112:115], v[212:227]
    ds_read_b64_tr_b16 v[96:97], v82 offset:18432
    ds_read_b64_tr_b16 v[98:99], v82 offset:18944
    s_waitcnt lgkmcnt(7)
    v_mfma_f32_32x32x16_bf16 v[180:195], v[120:123], v[116:119], v[180:195]
    ds_read_b128 v[100:103], v78 offset:49152
    ds_read_b64_tr_b16 v[104:105], v82 offset:4096
    ds_read_b64_tr_b16 v[106:107], v82 offset:4608
    v_mfma_f32_32x32x16_bf16 v[196:211], v[124:127], v[116:119], v[196:211]
    ds_read_b64_tr_b16 v[108:109], v82 offset:12288
    ds_read_b64_tr_b16 v[110:111], v82 offset:12800
    v_mfma_f32_32x32x16_bf16 v[212:227], v[116:119], v[128:131], v[212:227]
    ds_read_b64_tr_b16 v[112:113], v82 offset:20480
    ds_read_b64_tr_b16 v[114:115], v82 offset:20992
    s_waitcnt lgkmcnt(7)
    v_mfma_f32_32x32x16_bf16 v[180:195], v[88:91], v[84:87], v[180:195]
    ds_read_b128 v[116:119], v79 offset:49152
    ds_read_b64_tr_b16 v[120:121], v82 offset:6144
    ds_read_b64_tr_b16 v[122:123], v82 offset:6656
    v_mfma_f32_32x32x16_bf16 v[196:211], v[92:95], v[84:87], v[196:211]
    ds_read_b64_tr_b16 v[124:125], v82 offset:14336
    ds_read_b64_tr_b16 v[126:127], v82 offset:14848
    v_mfma_f32_32x32x16_bf16 v[212:227], v[84:87], v[96:99], v[212:227]
    ds_read_b64_tr_b16 v[128:129], v82 offset:22528
    ds_read_b64_tr_b16 v[130:131], v82 offset:23040
    s_waitcnt vmcnt(0)
    s_cmp_lg_u32 s62, 0
    s_cbranch_scc1 L_nw_c_ok
    s_mov_b32 s66, 0
L_nw_c:
    s_waitcnt vmcnt(0)
    v_readfirstlane_b32 s63, v13
    s_nop 0
    s_cmp_lg_u32 s63, 0
    s_cbranch_scc1 L_nw_c_ok
    s_sleep 16
    buffer_load_dwordx2 v[12:13], v3, s[56:59], 0 offen sc1
    s_add_u32 s66, s66, 1
    s_cmp_lt_u32 s66, 262144
    s_cbranch_scc1 L_nw_c
L_nw_c_ok:
    s_waitcnt lgkmcnt(0)
    s_barrier
    s_lshl_b32 s64, s60, 5
    s_add_u32 s64, s64, s61
    s_cmp_lg_u32 s62, 0
    s_cbranch_scc1 L_sig0
    s_lshl_b32 s63, s64, 3
    s_add_u32 s63, s63, 8454144
    s_mov_b64 exec, 1
    buffer_store_dwordx2 v[12:13], v3, s[36:39], s63 offen sc1
    s_mov_b64 exec, -1
L_sig0:
    v_mfma_f32_32x32x16_bf16 v[180:195], v[104:107], v[100:103], v[180:195]
    ds_read_b128 v[84:87], v76 offset:57344
    ds_read_b64_tr_b16 v[88:89], v83 offset:0
    ds_read_b64_tr_b16 v[90:91], v83 offset:512
    v_mfma_f32_32x32x16_bf16 v[196:211], v[108:111], v[100:103], v[196:211]
    ds_read_b64_tr_b16 v[92:93], v83 offset:8192
    ds_read_b64_tr_b16 v[94:95], v83 offset:8704
    v_mfma_f32_32x32x16_bf16 v[212:227], v[100:103], v[112:115], v[212:227]
    ds_read_b64_tr_b16 v[96:97], v83 offset:16384
    ds_read_b64_tr_b16 v[98:99], v83 offset:16896
    s_waitcnt lgkmcnt(7)
    v_mfma_f32_32x32x16_bf16 v[180:195], v[120:123], v[116:119], v[180:195]
    ds_read_b128 v[100:103], v77 offset:57344
    ds_read_b64_tr_b16 v[104:105], v83 offset:2048
    ds_read_b64_tr_b16 v[106:107], v83 offset:2560
    v_mfma_f32_32x32x16_bf16 v[196:211], v[124:127], v[116:119], v[196:211]
    ds_read_b64_tr_b16 v[108:109], v83 offset:10240
    ds_read_b64_tr_b16 v[110:111], v83 offset:10752
    v_mfma_f32_32x32x16_bf16 v[212:227], v[116:119], v[128:131], v[212:227]
    ds_read_b64_tr_b16 v[112:113], v83 offset:18432
    ds_read_b64_tr_b16 v[114:115], v83 offset:18944
    s_waitcnt lgkmcnt(7)
    v_mfma_f32_32x32x16_bf16 v[180:195], v[88:91], v[84:87], v[180:195]
    ds_read_b128 v[116:119], v78 offset:57344
    ds_read_b64_tr_b16 v[120:121], v83 offset:4096
    ds_read_b64_tr_b16 v[122:123], v83 offset:4608
    v_mfma_f32_32x32x16_bf16 v[196:211], v[92:95], v[84:87], v[196:211]
    ds_read_b64_tr_b16 v[124:125], v83 offset:12288
    ds_read_b64_tr_b16 v[126:127], v83 offset:12800
    v_mfma_f32_32x32x16_bf16 v[212:227], v[84:87], v[96:99], v[212:227]
    ds_read_b64_tr_b16 v[128:129], v83 offset:20480
    ds_read_b64_tr_b16 v[130:131], v83 offset:20992
    s_waitcnt lgkmcnt(7)
    v_mfma_f32_32x32x16_bf16 v[180:195], v[104:107], v[100:103], v[180:195]
    ds_read_b128 v[84:87], v79 offset:57344
    ds_read_b64_tr_b16 v[88:89], v83 offset:6144
    ds_read_b64_tr_b16 v[90:91], v83 offset:6656
    v_mfma_f32_32x32x16_bf16 v[196:211], v[108:111], v[100:103], v[196:211]
    ds_read_b64_tr_b16 v[92:93], v83 offset:14336
    ds_read_b64_tr_b16 v[94:95], v83 offset:14848
    v_mfma_f32_32x32x16_bf16 v[212:227], v[100:103], v[112:115], v[212:227]
    ds_read_b64_tr_b16 v[96:97], v83 offset:22528
    ds_read_b64_tr_b16 v[98:99], v83 offset:23040
    s_waitcnt lgkmcnt(7)
    v_mfma_f32_32x32x16_bf16 v[180:195], v[120:123], v[116:119], v[180:195]
    v_mfma_f32_32x32x16_bf16 v[196:211], v[124:127], v[116:119], v[196:211]
    v_mfma_f32_32x32x16_bf16 v[212:227], v[116:119], v[128:131], v[212:227]
    s_waitcnt lgkmcnt(0)
    v_mfma_f32_32x32x16_bf16 v[180:195], v[88:91], v[84:87], v[180:195]
    v_mfma_f32_32x32x16_bf16 v[196:211], v[92:95], v[84:87], v[196:211]
    v_mfma_f32_32x32x16_bf16 v[212:227], v[84:87], v[96:99], v[212:227]
    s_and_b32 s64, s62, 2
    s_lshl_b32 s64, s64, 11
    s_lshl_b32 s65, s69, 10
    s_add_u32 s64, s64, s65
    s_add_u32 s64, s64, 114688
    v_add_u32 v253, s64, v2
    ds_write_b128 v253, v[228:231]
    ds_write_b128 v253, v[232:235] offset:2048
    ds_write_b128 v253, v[236:239] offset:8192
    ds_write_b128 v253, v[240:243] offset:10240
    v_cvt_pk_bf16_f32 v132, v180, v181
    v_cvt_pk_bf16_f32 v133, v182, v183
    v_cvt_pk_bf16_f32 v134, v184, v185
    v_cvt_pk_bf16_f32 v135, v186, v187
    v_cvt_pk_bf16_f32 v136, v188, v189
    v_cvt_pk_bf16_f32 v137, v190, v191
    v_cvt_pk_bf16_f32 v138, v192, v193
    v_cvt_pk_bf16_f32 v139, v194, v195
    v_cvt_pk_bf16_f32 v140, v196, v197
    v_cvt_pk_bf16_f32 v141, v198, v199
    v_cvt_pk_bf16_f32 v142, v200, v201
    v_cvt_pk_bf16_f32 v143, v202, v203
    v_cvt_pk_bf16_f32 v144, v204, v205
    v_cvt_pk_bf16_f32 v145, v206, v207
    v_cvt_pk_bf16_f32 v146, v208, v209
    v_cvt_pk_bf16_f32 v147, v210, v211
    v_cvt_pk_bf16_f32 v148, v212, v213
    v_cvt_pk_bf16_f32 v149, v214, v215
    v_cvt_pk_bf16_f32 v150, v216, v217
    v_cvt_pk_bf16_f32 v151, v218, v219
    v_cvt_pk_bf16_f32 v152, v220, v221
    v_cvt_pk_bf16_f32 v153, v222, v223
    v_cvt_pk_bf16_f32 v154, v224, v225
    v_cvt_pk_bf16_f32 v155, v226, v227
    s_cmp_lg_u32 s62, 0
    s_cbranch_scc1 L_nonlds
    v_mov_b32 v252, 69632
    ds_write_b64 v252, v[12:13]
L_nonlds:
    s_mul_i32 s63, s62, 6144
    s_add_u32 s63, s63, 90112
    v_add_u32 v253, s63, v2
    ds_write_b128 v253, v[132:135] offset:0
    ds_write_b128 v253, v[136:139] offset:1024
    ds_write_b128 v253, v[140:143] offset:2048
    ds_write_b128 v253, v[144:147] offset:3072
    ds_write_b128 v253, v[148:151] offset:4096
    ds_write_b128 v253, v[152:155] offset:5120
    s_waitcnt lgkmcnt(0)
    s_barrier
    s_branch L_common
L_loader:
    s_sub_u32 s66, s62, 4
    v_lshrrev_b32 v4, 3, v1
    v_and_b32 v5, 7, v1
    v_bfe_u32 v6, v1, 4, 1
    v_lshlrev_b32 v6, 2, v6
    v_xor_b32 v5, v5, v6
    v_lshlrev_b32 v5, 4, v5
    v_mul_u32_u24 v78, 3072, v4
    v_add_u32 v78, v78, v5
    s_lshl_b32 s80, s61, 16
    s_lshl_b32 s63, s66, 14
    s_add_u32 s80, s80, s63
    s_lshl_b32 s82, s66, 11
    s_mul_i32 s81, s66, 49152
    s_lshl_b32 s63, s60, 7
    s_add_u32 s81, s81, s63
    s_lshl_b32 s83, s66, 11
    s_add_u32 s83, s83, 65536
    s_cmp_lg_u32 s62, 7
    s_cbranch_scc1 L_nocpf
    s_getpc_b64 s[78:79]
L_pc:
    s_sub_u32 s78, s78, L_pc-gated_mix__linear_kernel_hedgehog__softmax_full_mha__prompt_kernel
    s_subb_u32 s79, s79, 0
    s_bfe_u32 s63, s2, 0x20003
    s_lshl_b32 s63, s63, 13
    v_lshlrev_b32 v79, 7, v1
    v_add_u32 v79, s63, v79
    v_min_u32 v79, L_end-gated_mix__linear_kernel_hedgehog__softmax_full_mha__prompt_kernel, v79
    global_load_dword v148, v79, s[78:79]
L_nocpf:
    s_waitcnt lgkmcnt(0)
    s_mov_b32 s28, s4
    s_and_b32 s29, s5, 0xffff
    s_mov_b32 s30, 2097152
    s_mov_b32 s31, 0x00020000
    s_mov_b32 s32, s14
    s_and_b32 s33, s15, 0xffff
    s_mov_b32 s34, 1572864
    s_mov_b32 s35, 0x00020000
    s_add_u32 s63, s68, 0
    s_and_b32 s63, s63, 7
    s_mul_i32 s85, s63, 196608
    s_add_u32 s85, s85, s81
    s_add_u32 m0, s83, 0
    s_add_u32 s72, s85, 0
    buffer_load_dwordx4 v78, s[32:35], s72 offen lds
    s_add_u32 m0, s83, 1024
    s_add_u32 s72, s85, 24576
    buffer_load_dwordx4 v78, s[32:35], s72 offen lds
    s_add_u32 m0, s83, 8192
    s_add_u32 s72, s85, 1024
    buffer_load_dwordx4 v78, s[32:35], s72 offen lds
    s_add_u32 m0, s83, 9216
    s_add_u32 s72, s85, 25600
    buffer_load_dwordx4 v78, s[32:35], s72 offen lds
    s_add_u32 m0, s83, 16384
    s_add_u32 s72, s85, 2048
    buffer_load_dwordx4 v78, s[32:35], s72 offen lds
    s_add_u32 m0, s83, 17408
    s_add_u32 s72, s85, 26624
    buffer_load_dwordx4 v78, s[32:35], s72 offen lds
    s_add_u32 s63, s68, 1
    s_and_b32 s63, s63, 7
    s_mul_i32 s85, s63, 196608
    s_add_u32 s85, s85, s81
    s_add_u32 m0, s83, 24576
    s_add_u32 s72, s85, 0
    buffer_load_dwordx4 v78, s[32:35], s72 offen lds
    s_add_u32 m0, s83, 25600
    s_add_u32 s72, s85, 24576
    buffer_load_dwordx4 v78, s[32:35], s72 offen lds
    s_add_u32 m0, s83, 32768
    s_add_u32 s72, s85, 1024
    buffer_load_dwordx4 v78, s[32:35], s72 offen lds
    s_add_u32 m0, s83, 33792
    s_add_u32 s72, s85, 25600
    buffer_load_dwordx4 v78, s[32:35], s72 offen lds
    s_add_u32 m0, s83, 40960
    s_add_u32 s72, s85, 2048
    buffer_load_dwordx4 v78, s[32:35], s72 offen lds
    s_add_u32 m0, s83, 41984
    s_add_u32 s72, s85, 26624
    buffer_load_dwordx4 v78, s[32:35], s72 offen lds
    s_mov_b32 s44, s6
    s_and_b32 s45, s7, 0xffff
    s_mov_b32 s46, 1572864
    s_mov_b32 s47, 0x00020000
    s_mov_b32 s36, s24
    s_and_b32 s37, s25, 0xffff
    s_mov_b32 s38, 16777216
    s_mov_b32 s39, 0x00020000
    s_mov_b32 s40, s8
    s_and_b32 s41, s9, 0xffff
    s_mov_b32 s42, 16384
    s_mov_b32 s43, 0x00020000
    s_mov_b32 s48, s18
    s_and_b32 s49, s19, 0xffff
    s_mov_b32 s50, 1024
    s_mov_b32 s51, 0x00020000
    s_mov_b32 s56, s22
    s_and_b32 s57, s23, 0xffff
    s_mov_b32 s58, 256
    s_mov_b32 s59, 0x00020000
    s_mov_b32 s52, s20
    s_and_b32 s53, s21, 0xffff
    s_mov_b32 s54, 2097152
    s_mov_b32 s55, 0x00020000
    s_and_b32 s69, s62, 1
    s_lshl_b32 s70, s61, 1
    s_add_u32 s70, s70, s69
    s_and_b32 s71, s62, 3
    s_lshl_b32 s63, s60, 2
    s_add_u32 s71, s71, s63
    s_and_b32 s63, s62, 1
    s_lshl_b32 s63, s63, 4
    s_lshl_b32 s76, 0xffff, s63
    s_mov_b32 s77, s76
    v_lshrrev_b32 v4, 3, v1
    v_and_b32 v5, 7, v1
    v_lshrrev_b32 v6, 1, v4
    v_xor_b32 v7, v5, v6
    v_lshlrev_b32 v7, 4, v7
    v_lshl_add_u32 v76, v4, 10, v7
    v_xor_b32 v77, 64, v76
    s_and_b32 s63, s61, 15
    s_lshl_b32 s63, s63, 2
    s_add_u32 s63, s63, s66
    s_mul_i32 s63, s63, 8
    s_mul_i32 s63, s63, 3072
    s_lshl_b32 s64, s60, 7
    s_add_u32 s63, s63, s64
    v_lshlrev_b32 v79, 10, v1
    v_cmp_gt_u32 vcc, 24, v1
    v_mov_b32 v4, 0x40000000
    s_nop 0
    v_cndmask_b32 v79, v4, v79, vcc
    buffer_load_dword v148, v79, s[44:47], s63 offen
    v_and_b32 v4, 31, v1
    v_lshrrev_b32 v5, 5, v1
    v_lshlrev_b32 v5, 2, v5
    v_sub_u32 v4, v4, v5
    v_mov_b32 v6, 0x3f80
    v_mov_b32 v7, 0x3f800000
    v_cmp_eq_u32 vcc, 0, v4
    s_nop 1
    v_cndmask_b32 v28, 0, v6, vcc
    v_cmp_eq_u32 vcc, 1, v4
    s_nop 1
    v_cndmask_b32 v28, v28, v7, vcc
    v_cmp_eq_u32 vcc, 2, v4
    s_nop 1
    v_cndmask_b32 v29, 0, v6, vcc
    v_cmp_eq_u32 vcc, 3, v4
    s_nop 1
    v_cndmask_b32 v29, v29, v7, vcc
    v_cmp_eq_u32 vcc, 8, v4
    s_nop 1
    v_cndmask_b32 v30, 0, v6, vcc
    v_cmp_eq_u32 vcc, 9, v4
    s_nop 1
    v_cndmask_b32 v30, v30, v7, vcc
    v_cmp_eq_u32 vcc, 10, v4
    s_nop 1
    v_cndmask_b32 v31, 0, v6, vcc
    v_cmp_eq_u32 vcc, 11, v4
    s_nop 1
    v_cndmask_b32 v31, v31, v7, vcc
    v_cmp_eq_u32 vcc, 16, v4
    s_nop 1
    v_cndmask_b32 v32, 0, v6, vcc
    v_cmp_eq_u32 vcc, 17, v4
    s_nop 1
    v_cndmask_b32 v32, v32, v7, vcc
    v_cmp_eq_u32 vcc, 18, v4
    s_nop 1
    v_cndmask_b32 v33, 0, v6, vcc
    v_cmp_eq_u32 vcc, 19, v4
    s_nop 1
    v_cndmask_b32 v33, v33, v7, vcc
    v_cmp_eq_u32 vcc, 24, v4
    s_nop 1
    v_cndmask_b32 v34, 0, v6, vcc
    v_cmp_eq_u32 vcc, 25, v4
    s_nop 1
    v_cndmask_b32 v34, v34, v7, vcc
    v_cmp_eq_u32 vcc, 26, v4
    s_nop 1
    v_cndmask_b32 v35, 0, v6, vcc
    v_cmp_eq_u32 vcc, 27, v4
    s_nop 1
    v_cndmask_b32 v35, v35, v7, vcc
    v_and_b32 v17, 15, v1
    v_lshlrev_b32 v17, 4, v17
    v_lshrrev_b32 v5, 5, v1
    v_lshl_add_u32 v17, v5, 8, v17
    v_and_b32 v5, 3, v1
    v_lshlrev_b32 v4, 5, v5
    v_add_u32 v150, 65536, v4
    v_lshlrev_b32 v151, 7, v1
    s_lshl_b32 s63, s60, 11
    v_min_u32 v151, 1920, v151
    buffer_load_dword v148, v151, s[40:43], s63 offen
    buffer_load_dword v148, v151, s[48:51], 0 offen
    v_lshrrev_b32 v6, 2, v1
    s_lshl_b32 s63, s66, 4
    v_add_u32 v6, s63, v6
    v_bfe_u32 v7, v6, 1, 3
    v_lshlrev_b32 v5, 1, v5
    v_xor_b32 v5, v5, v7
    v_lshlrev_b32 v7, 7, v6
    v_lshl_add_u32 v144, v5, 4, v7
    v_xor_b32 v145, 16, v144
    v_lshlrev_b32 v149, 2, v6
    v_mov_b32 v146, 0
    s_waitcnt vmcnt(9)
    s_barrier
    s_add_u32 s63, s68, 2
    s_and_b32 s63, s63, 7
    s_mul_i32 s85, s63, 196608
    s_add_u32 s85, s85, s81
    s_add_u32 m0, s83, 49152
    s_add_u32 s72, s85, 0
    buffer_load_dwordx4 v78, s[32:35], s72 offen lds
    s_add_u32 m0, s83, 50176
    s_add_u32 s72, s85, 24576
    buffer_load_dwordx4 v78, s[32:35], s72 offen lds
    s_add_u32 m0, s83, 57344
    s_add_u32 s72, s85, 1024
    buffer_load_dwordx4 v78, s[32:35], s72 offen lds
    s_add_u32 m0, s83, 58368
    s_add_u32 s72, s85, 25600
    buffer_load_dwordx4 v78, s[32:35], s72 offen lds
    s_add_u32 m0, s83, 65536
    s_add_u32 s72, s85, 2048
    buffer_load_dwordx4 v78, s[32:35], s72 offen lds
    s_add_u32 m0, s83, 66560
    s_add_u32 s72, s85, 26624
    buffer_load_dwordx4 v78, s[32:35], s72 offen lds
    s_add_u32 s63, s68, 3
    s_and_b32 s63, s63, 7
    s_mul_i32 s85, s63, 196608
    s_add_u32 s85, s85, s81
    s_add_u32 m0, s83, 73728
    s_add_u32 s72, s85, 0
    buffer_load_dwordx4 v78, s[32:35], s72 offen lds
    s_add_u32 m0, s83, 74752
    s_add_u32 s72, s85, 24576
    buffer_load_dwordx4 v78, s[32:35], s72 offen lds
    s_add_u32 m0, s83, 81920
    s_add_u32 s72, s85, 1024
    buffer_load_dwordx4 v78, s[32:35], s72 offen lds
    s_add_u32 m0, s83, 82944
    s_add_u32 s72, s85, 25600
    buffer_load_dwordx4 v78, s[32:35], s72 offen lds
    s_add_u32 m0, s83, 90112
    s_add_u32 s72, s85, 2048
    buffer_load_dwordx4 v78, s[32:35], s72 offen lds
    s_add_u32 m0, s83, 91136
    s_add_u32 s72, s85, 26624
    buffer_load_dwordx4 v78, s[32:35], s72 offen lds
    s_waitcnt vmcnt(15)
    s_barrier
    s_add_u32 s63, s68, 4
    s_and_b32 s63, s63, 7
    s_lshl_b32 s84, s63, 7
    s_add_u32 s84, s84, s80
    s_add_u32 m0, s82, 32768
    s_add_u32 s72, s84, 0
    buffer_load_dwordx4 v76, s[28:31], s72 offen lds
    s_add_u32 m0, s82, 33792
    s_add_u32 s72, s84, 8192
    buffer_load_dwordx4 v77, s[28:31], s72 offen lds
    s_add_u32 s63, s68, 4
    s_and_b32 s63, s63, 7
    s_mul_i32 s85, s63, 196608
    s_add_u32 s85, s85, s81
    s_add_u32 m0, s83, 0
    s_add_u32 s72, s85, 0
    buffer_load_dwordx4 v78, s[32:35], s72 offen lds
    s_add_u32 m0, s83, 1024
    s_add_u32 s72, s85, 24576
    buffer_load_dwordx4 v78, s[32:35], s72 offen lds
    s_add_u32 m0, s83, 8192
    s_add_u32 s72, s85, 1024
    buffer_load_dwordx4 v78, s[32:35], s72 offen lds
    s_add_u32 m0, s83, 9216
    s_add_u32 s72, s85, 25600
    buffer_load_dwordx4 v78, s[32:35], s72 offen lds
    s_add_u32 m0, s83, 16384
    s_add_u32 s72, s85, 2048
    buffer_load_dwordx4 v78, s[32:35], s72 offen lds
    s_add_u32 m0, s83, 17408
    s_add_u32 s72, s85, 26624
    buffer_load_dwordx4 v78, s[32:35], s72 offen lds
    s_waitcnt vmcnt(14)
    s_barrier
    s_add_u32 s63, s68, 5
    s_and_b32 s63, s63, 7
    s_lshl_b32 s84, s63, 7
    s_add_u32 s84, s84, s80
    s_add_u32 m0, s82, 40960
    s_add_u32 s72, s84, 0
    buffer_load_dwordx4 v76, s[28:31], s72 offen lds
    s_add_u32 m0, s82, 41984
    s_add_u32 s72, s84, 8192
    buffer_load_dwordx4 v77, s[28:31], s72 offen lds
    s_add_u32 s63, s68, 5
    s_and_b32 s63, s63, 7
    s_mul_i32 s85, s63, 196608
    s_add_u32 s85, s85, s81
    s_add_u32 m0, s83, 24576
    s_add_u32 s72, s85, 0
    buffer_load_dwordx4 v78, s[32:35], s72 offen lds
    s_add_u32 m0, s83, 25600
    s_add_u32 s72, s85, 24576
    buffer_load_dwordx4 v78, s[32:35], s72 offen lds
    s_add_u32 m0, s83, 32768
    s_add_u32 s72, s85, 1024
    buffer_load_dwordx4 v78, s[32:35], s72 offen lds
    s_add_u32 m0, s83, 33792
    s_add_u32 s72, s85, 25600
    buffer_load_dwordx4 v78, s[32:35], s72 offen lds
    s_add_u32 m0, s83, 40960
    s_add_u32 s72, s85, 2048
    buffer_load_dwordx4 v78, s[32:35], s72 offen lds
    s_add_u32 m0, s83, 41984
    s_add_u32 s72, s85, 26624
    buffer_load_dwordx4 v78, s[32:35], s72 offen lds
    s_waitcnt vmcnt(16)
    s_barrier
    s_add_u32 s63, s68, 6
    s_and_b32 s63, s63, 7
    s_lshl_b32 s84, s63, 7
    s_add_u32 s84, s84, s80
    s_add_u32 m0, s82, 49152
    s_add_u32 s72, s84, 0
    buffer_load_dwordx4 v76, s[28:31], s72 offen lds
    s_add_u32 m0, s82, 50176
    s_add_u32 s72, s84, 8192
    buffer_load_dwordx4 v77, s[28:31], s72 offen lds
    s_add_u32 s63, s68, 6
    s_and_b32 s63, s63, 7
    s_mul_i32 s85, s63, 196608
    s_add_u32 s85, s85, s81
    s_add_u32 m0, s83, 49152
    s_add_u32 s72, s85, 0
    buffer_load_dwordx4 v78, s[32:35], s72 offen lds
    s_add_u32 m0, s83, 50176
    s_add_u32 s72, s85, 24576
    buffer_load_dwordx4 v78, s[32:35], s72 offen lds
    s_add_u32 m0, s83, 57344
    s_add_u32 s72, s85, 1024
    buffer_load_dwordx4 v78, s[32:35], s72 offen lds
    s_add_u32 m0, s83, 58368
    s_add_u32 s72, s85, 25600
    buffer_load_dwordx4 v78, s[32:35], s72 offen lds
    s_add_u32 m0, s83, 65536
    s_add_u32 s72, s85, 2048
    buffer_load_dwordx4 v78, s[32:35], s72 offen lds
    s_add_u32 m0, s83, 66560
    s_add_u32 s72, s85, 26624
    buffer_load_dwordx4 v78, s[32:35], s72 offen lds
    s_waitcnt vmcnt(16)
    s_barrier
    s_add_u32 s63, s68, 7
    s_and_b32 s63, s63, 7
    s_lshl_b32 s84, s63, 7
    s_add_u32 s84, s84, s80
    s_add_u32 m0, s82, 57344
    s_add_u32 s72, s84, 0
    buffer_load_dwordx4 v76, s[28:31], s72 offen lds
    s_add_u32 m0, s82, 58368
    s_add_u32 s72, s84, 8192
    buffer_load_dwordx4 v77, s[28:31], s72 offen lds
    s_add_u32 s63, s68, 7
    s_and_b32 s63, s63, 7
    s_mul_i32 s85, s63, 196608
    s_add_u32 s85, s85, s81
    s_add_u32 m0, s83, 73728
    s_add_u32 s72, s85, 0
    buffer_load_dwordx4 v78, s[32:35], s72 offen lds
    s_add_u32 m0, s83, 74752
    s_add_u32 s72, s85, 24576
    buffer_load_dwordx4 v78, s[32:35], s72 offen lds
    s_add_u32 m0, s83, 81920
    s_add_u32 s72, s85, 1024
    buffer_load_dwordx4 v78, s[32:35], s72 offen lds
    s_add_u32 m0, s83, 82944
    s_add_u32 s72, s85, 25600
    buffer_load_dwordx4 v78, s[32:35], s72 offen lds
    s_add_u32 m0, s83, 90112
    s_add_u32 s72, s85, 2048
    buffer_load_dwordx4 v78, s[32:35], s72 offen lds
    s_add_u32 m0, s83, 91136
    s_add_u32 s72, s85, 26624
    buffer_load_dwordx4 v78, s[32:35], s72 offen lds
    s_waitcnt vmcnt(16)
    s_barrier
    s_add_u32 s63, s68, 8
    s_and_b32 s63, s63, 7
    s_mul_i32 s85, s63, 196608
    s_add_u32 s85, s85, s81
    s_add_u32 m0, s83, 0
    s_add_u32 s72, s85, 0
    buffer_load_dwordx4 v78, s[44:47], s72 offen lds
    s_add_u32 m0, s83, 1024
    s_add_u32 s72, s85, 24576
    buffer_load_dwordx4 v78, s[44:47], s72 offen lds
    s_add_u32 m0, s83, 8192
    s_add_u32 s72, s85, 1024
    buffer_load_dwordx4 v78, s[44:47], s72 offen lds
    s_add_u32 m0, s83, 9216
    s_add_u32 s72, s85, 25600
    buffer_load_dwordx4 v78, s[44:47], s72 offen lds
    s_add_u32 m0, s83, 16384
    s_add_u32 s72, s85, 2048
    buffer_load_dwordx4 v78, s[44:47], s72 offen lds
    s_add_u32 m0, s83, 17408
    s_add_u32 s72, s85, 26624
    buffer_load_dwordx4 v78, s[44:47], s72 offen lds
    s_waitcnt vmcnt(14)
    s_barrier
    s_add_u32 s63, s68, 9
    s_and_b32 s63, s63, 7
    s_mul_i32 s85, s63, 196608
    s_add_u32 s85, s85, s81
    s_add_u32 m0, s83, 24576
    s_add_u32 s72, s85, 0
    buffer_load_dwordx4 v78, s[44:47], s72 offen lds
    s_add_u32 m0, s83, 25600
    s_add_u32 s72, s85, 24576
    buffer_load_dwordx4 v78, s[44:47], s72 offen lds
    s_add_u32 m0, s83, 32768
    s_add_u32 s72, s85, 1024
    buffer_load_dwordx4 v78, s[44:47], s72 offen lds
    s_add_u32 m0, s83, 33792
    s_add_u32 s72, s85, 25600
    buffer_load_dwordx4 v78, s[44:47], s72 offen lds
    s_add_u32 m0, s83, 40960
    s_add_u32 s72, s85, 2048
    buffer_load_dwordx4 v78, s[44:47], s72 offen lds
    s_add_u32 m0, s83, 41984
    s_add_u32 s72, s85, 26624
    buffer_load_dwordx4 v78, s[44:47], s72 offen lds
    s_waitcnt vmcnt(12)
    s_barrier
    s_add_u32 s63, s68, 10
    s_and_b32 s63, s63, 7
    s_mul_i32 s85, s63, 196608
    s_add_u32 s85, s85, s81
    s_add_u32 m0, s83, 49152
    s_add_u32 s72, s85, 0
    buffer_load_dwordx4 v78, s[44:47], s72 offen lds
    s_add_u32 m0, s83, 50176
    s_add_u32 s72, s85, 24576
    buffer_load_dwordx4 v78, s[44:47], s72 offen lds
    s_add_u32 m0, s83, 57344
    s_add_u32 s72, s85, 1024
    buffer_load_dwordx4 v78, s[44:47], s72 offen lds
    s_add_u32 m0, s83, 58368
    s_add_u32 s72, s85, 25600
    buffer_load_dwordx4 v78, s[44:47], s72 offen lds
    s_add_u32 m0, s83, 65536
    s_add_u32 s72, s85, 2048
    buffer_load_dwordx4 v78, s[44:47], s72 offen lds
    s_add_u32 m0, s83, 66560
    s_add_u32 s72, s85, 26624
    buffer_load_dwordx4 v78, s[44:47], s72 offen lds
    s_waitcnt vmcnt(12)
    s_barrier
    s_add_u32 s63, s68, 11
    s_and_b32 s63, s63, 7
    s_mul_i32 s85, s63, 196608
    s_add_u32 s85, s85, s81
    s_add_u32 m0, s83, 73728
    s_add_u32 s72, s85, 0
    buffer_load_dwordx4 v78, s[44:47], s72 offen lds
    s_add_u32 m0, s83, 74752
    s_add_u32 s72, s85, 24576
    buffer_load_dwordx4 v78, s[44:47], s72 offen lds
    s_add_u32 m0, s83, 81920
    s_add_u32 s72, s85, 1024
    buffer_load_dwordx4 v78, s[44:47], s72 offen lds
    s_add_u32 m0, s83, 82944
    s_add_u32 s72, s85, 25600
    buffer_load_dwordx4 v78, s[44:47], s72 offen lds
    s_add_u32 m0, s83, 90112
    s_add_u32 s72, s85, 2048
    buffer_load_dwordx4 v78, s[44:47], s72 offen lds
    s_add_u32 m0, s83, 91136
    s_add_u32 s72, s85, 26624
    buffer_load_dwordx4 v78, s[44:47], s72 offen lds
    s_waitcnt vmcnt(12)
    s_barrier
    s_add_u32 s63, s68, 12
    s_and_b32 s63, s63, 7
    s_mul_i32 s85, s63, 196608
    s_add_u32 s85, s85, s81
    s_add_u32 m0, s83, 0
    s_add_u32 s72, s85, 0
    buffer_load_dwordx4 v78, s[44:47], s72 offen lds
    s_add_u32 m0, s83, 1024
    s_add_u32 s72, s85, 24576
    buffer_load_dwordx4 v78, s[44:47], s72 offen lds
    s_add_u32 m0, s83, 8192
    s_add_u32 s72, s85, 1024
    buffer_load_dwordx4 v78, s[44:47], s72 offen lds
    s_add_u32 m0, s83, 9216
    s_add_u32 s72, s85, 25600
    buffer_load_dwordx4 v78, s[44:47], s72 offen lds
    s_add_u32 m0, s83, 16384
    s_add_u32 s72, s85, 2048
    buffer_load_dwordx4 v78, s[44:47], s72 offen lds
    s_add_u32 m0, s83, 17408
    s_add_u32 s72, s85, 26624
    buffer_load_dwordx4 v78, s[44:47], s72 offen lds
    s_waitcnt vmcnt(12)
    s_barrier
    s_add_u32 s63, s68, 13
    s_and_b32 s63, s63, 7
    s_mul_i32 s85, s63, 196608
    s_add_u32 s85, s85, s81
    s_add_u32 m0, s83, 24576
    s_add_u32 s72, s85, 0
    buffer_load_dwordx4 v78, s[44:47], s72 offen lds
    s_add_u32 m0, s83, 25600
    s_add_u32 s72, s85, 24576
    buffer_load_dwordx4 v78, s[44:47], s72 offen lds
    s_add_u32 m0, s83, 32768
    s_add_u32 s72, s85, 1024
    buffer_load_dwordx4 v78, s[44:47], s72 offen lds
    s_add_u32 m0, s83, 33792
    s_add_u32 s72, s85, 25600
    buffer_load_dwordx4 v78, s[44:47], s72 offen lds
    s_add_u32 m0, s83, 40960
    s_add_u32 s72, s85, 2048
    buffer_load_dwordx4 v78, s[44:47], s72 offen lds
    s_add_u32 m0, s83, 41984
    s_add_u32 s72, s85, 26624
    buffer_load_dwordx4 v78, s[44:47], s72 offen lds
    s_waitcnt vmcnt(12)
    s_barrier
    s_add_u32 s63, s68, 14
    s_and_b32 s63, s63, 7
    s_mul_i32 s85, s63, 196608
    s_add_u32 s85, s85, s81
    s_add_u32 m0, s83, 49152
    s_add_u32 s72, s85, 0
    buffer_load_dwordx4 v78, s[44:47], s72 offen lds
    s_add_u32 m0, s83, 50176
    s_add_u32 s72, s85, 24576
    buffer_load_dwordx4 v78, s[44:47], s72 offen lds
    s_add_u32 m0, s83, 57344
    s_add_u32 s72, s85, 1024
    buffer_load_dwordx4 v78, s[44:47], s72 offen lds
    s_add_u32 m0, s83, 58368
    s_add_u32 s72, s85, 25600
    buffer_load_dwordx4 v78, s[44:47], s72 offen lds
    s_add_u32 m0, s83, 65536
    s_add_u32 s72, s85, 2048
    buffer_load_dwordx4 v78, s[44:47], s72 offen lds
    s_add_u32 m0, s83, 66560
    s_add_u32 s72, s85, 26624
    buffer_load_dwordx4 v78, s[44:47], s72 offen lds
    s_waitcnt vmcnt(12)
    s_barrier
    s_add_u32 s63, s68, 15
    s_and_b32 s63, s63, 7
    s_mul_i32 s85, s63, 196608
    s_add_u32 s85, s85, s81
    s_add_u32 m0, s83, 73728
    s_add_u32 s72, s85, 0
    buffer_load_dwordx4 v78, s[44:47], s72 offen lds
    s_add_u32 m0, s83, 74752
    s_add_u32 s72, s85, 24576
    buffer_load_dwordx4 v78, s[44:47], s72 offen lds
    s_add_u32 m0, s83, 81920
    s_add_u32 s72, s85, 1024
    buffer_load_dwordx4 v78, s[44:47], s72 offen lds
    s_add_u32 m0, s83, 82944
    s_add_u32 s72, s85, 25600
    buffer_load_dwordx4 v78, s[44:47], s72 offen lds
    s_add_u32 m0, s83, 90112
    s_add_u32 s72, s85, 2048
    buffer_load_dwordx4 v78, s[44:47], s72 offen lds
    s_add_u32 m0, s83, 91136
    s_add_u32 s72, s85, 26624
    buffer_load_dwordx4 v78, s[44:47], s72 offen lds
    s_waitcnt vmcnt(12)
    s_barrier
    s_cmp_eq_u32 s66, 1
    s_cbranch_scc1 L_sd1
    s_cmp_eq_u32 s66, 2
    s_cbranch_scc1 L_sd1
    s_mov_b32 m0, 65536
    s_nop 0
    buffer_load_dwordx4 v2, s[48:51], 0 offen lds
    s_branch L_sd2
L_sd1:
    s_lshl_b32 s63, s66, 10
    s_add_u32 m0, s63, 65536
    s_lshl_b32 s64, s60, 11
    s_add_u32 s63, s63, s64
    s_sub_u32 s63, s63, 1024
    buffer_load_dwordx4 v2, s[40:43], s63 offen lds
L_sd2:
    s_waitcnt vmcnt(7)
    s_barrier
    s_bitcmp1_b32 s2, 7
    s_cselect_b32 s48, s16, s10
    s_cselect_b32 s49, s17, s11
    s_and_b32 s49, s49, 0xffff
    s_mov_b32 s50, 524288
    s_bfe_u32 s63, s2, 0x40003
    s_lshl_b32 s63, s63, 2
    s_add_u32 s63, s63, s66
    s_lshl_b32 s63, s63, 13
    v_lshlrev_b32 v79, 7, v1
    buffer_load_dword v148, v79, s[48:51], s63 offen
    s_waitcnt vmcnt(1)
    s_barrier
    s_add_u32 s63, s68, 0
    s_and_b32 s63, s63, 7
    s_lshl_b32 s63, s63, 7
    v_add_u32 v151, s63, v150
    ds_read_b128 v[112:115], v144 offset:0
    ds_read_b128 v[116:119], v145 offset:0
    ds_read_b128 v[80:83], v151
    ds_read_b128 v[84:87], v151 offset:16
    s_add_u32 s63, s68, 1
    s_and_b32 s63, s63, 7
    s_lshl_b32 s63, s63, 7
    v_add_u32 v151, s63, v150
    ds_read_b128 v[120:123], v144 offset:8192
    ds_read_b128 v[124:127], v145 offset:8192
    ds_read_b128 v[88:91], v151
    ds_read_b128 v[92:95], v151 offset:16
    s_add_u32 s63, s68, 2
    s_and_b32 s63, s63, 7
    s_lshl_b32 s63, s63, 7
    v_add_u32 v151, s63, v150
    ds_read_b128 v[128:131], v144 offset:16384
    ds_read_b128 v[132:135], v145 offset:16384
    ds_read_b128 v[96:99], v151
    ds_read_b128 v[100:103], v151 offset:16
    s_waitcnt lgkmcnt(8)
    s_add_u32 s63, s68, 3
    s_and_b32 s63, s63, 7
    s_lshl_b32 s63, s63, 7
    v_add_u32 v151, s63, v150
    ds_read_b128 v[136:139], v144 offset:24576
    ds_read_b128 v[140:143], v145 offset:24576
    ds_read_b128 v[104:107], v151
    ds_read_b128 v[108:111], v151 offset:16
    s_waitcnt lgkmcnt(12)
    v_dot2_f32_bf16 v146, v112, v80, v146
    v_dot2_f32_bf16 v146, v113, v81, v146
    v_dot2_f32_bf16 v146, v114, v82, v146
    v_dot2_f32_bf16 v146, v115, v83, v146
    v_dot2_f32_bf16 v146, v116, v84, v146
    v_dot2_f32_bf16 v146, v117, v85, v146
    v_dot2_f32_bf16 v146, v118, v86, v146
    v_dot2_f32_bf16 v146, v119, v87, v146
    s_waitcnt lgkmcnt(8)
    v_dot2_f32_bf16 v146, v120, v88, v146
    v_dot2_f32_bf16 v146, v121, v89, v146
    v_dot2_f32_bf16 v146, v122, v90, v146
    v_dot2_f32_bf16 v146, v123, v91, v146
    v_dot2_f32_bf16 v146, v124, v92, v146
    v_dot2_f32_bf16 v146, v125, v93, v146
    v_dot2_f32_bf16 v146, v126, v94, v146
    v_dot2_f32_bf16 v146, v127, v95, v146
    s_waitcnt lgkmcnt(4)
    v_dot2_f32_bf16 v146, v128, v96, v146
    v_dot2_f32_bf16 v146, v129, v97, v146
    v_dot2_f32_bf16 v146, v130, v98, v146
    v_dot2_f32_bf16 v146, v131, v99, v146
    v_dot2_f32_bf16 v146, v132, v100, v146
    v_dot2_f32_bf16 v146, v133, v101, v146
    v_dot2_f32_bf16 v146, v134, v102, v146
    v_dot2_f32_bf16 v146, v135, v103, v146
    s_waitcnt lgkmcnt(0)
    v_dot2_f32_bf16 v146, v136, v104, v146
    v_dot2_f32_bf16 v146, v137, v105, v146
    v_dot2_f32_bf16 v146, v138, v106, v146
    v_dot2_f32_bf16 v146, v139, v107, v146
    v_dot2_f32_bf16 v146, v140, v108, v146
    v_dot2_f32_bf16 v146, v141, v109, v146
    v_dot2_f32_bf16 v146, v142, v110, v146
    v_dot2_f32_bf16 v146, v143, v111, v146
    s_add_u32 s63, s68, 4
    s_and_b32 s63, s63, 7
    s_lshl_b32 s63, s63, 7
    v_add_u32 v151, s63, v150
    ds_read_b128 v[112:115], v144 offset:32768
    ds_read_b128 v[116:119], v145 offset:32768
    ds_read_b128 v[80:83], v151
    ds_read_b128 v[84:87], v151 offset:16
    s_add_u32 s63, s68, 5
    s_and_b32 s63, s63, 7
    s_lshl_b32 s63, s63, 7
    v_add_u32 v151, s63, v150
    ds_read_b128 v[120:123], v144 offset:40960
    ds_read_b128 v[124:127], v145 offset:40960
    ds_read_b128 v[88:91], v151
    ds_read_b128 v[92:95], v151 offset:16
    s_add_u32 s63, s68, 6
    s_and_b32 s63, s63, 7
    s_lshl_b32 s63, s63, 7
    v_add_u32 v151, s63, v150
    ds_read_b128 v[128:131], v144 offset:49152
    ds_read_b128 v[132:135], v145 offset:49152
    ds_read_b128 v[96:99], v151
    ds_read_b128 v[100:103], v151 offset:16
    s_waitcnt lgkmcnt(8)
    s_add_u32 s63, s68, 7
    s_and_b32 s63, s63, 7
    s_lshl_b32 s63, s63, 7
    v_add_u32 v151, s63, v150
    ds_read_b128 v[136:139], v144 offset:57344
    ds_read_b128 v[140:143], v145 offset:57344
    ds_read_b128 v[104:107], v151
    ds_read_b128 v[108:111], v151 offset:16
    s_waitcnt lgkmcnt(12)
    v_dot2_f32_bf16 v146, v112, v80, v146
    v_dot2_f32_bf16 v146, v113, v81, v146
    v_dot2_f32_bf16 v146, v114, v82, v146
    v_dot2_f32_bf16 v146, v115, v83, v146
    v_dot2_f32_bf16 v146, v116, v84, v146
    v_dot2_f32_bf16 v146, v117, v85, v146
    v_dot2_f32_bf16 v146, v118, v86, v146
    v_dot2_f32_bf16 v146, v119, v87, v146
    s_waitcnt lgkmcnt(8)
    v_dot2_f32_bf16 v146, v120, v88, v146
    v_dot2_f32_bf16 v146, v121, v89, v146
    v_dot2_f32_bf16 v146, v122, v90, v146
    v_dot2_f32_bf16 v146, v123, v91, v146
    v_dot2_f32_bf16 v146, v124, v92, v146
    v_dot2_f32_bf16 v146, v125, v93, v146
    v_dot2_f32_bf16 v146, v126, v94, v146
    v_dot2_f32_bf16 v146, v127, v95, v146
    s_waitcnt lgkmcnt(4)
    v_dot2_f32_bf16 v146, v128, v96, v146
    v_dot2_f32_bf16 v146, v129, v97, v146
    v_dot2_f32_bf16 v146, v130, v98, v146
    v_dot2_f32_bf16 v146, v131, v99, v146
    v_dot2_f32_bf16 v146, v132, v100, v146
    v_dot2_f32_bf16 v146, v133, v101, v146
    v_dot2_f32_bf16 v146, v134, v102, v146
    v_dot2_f32_bf16 v146, v135, v103, v146
    s_waitcnt lgkmcnt(0)
    v_dot2_f32_bf16 v146, v136, v104, v146
    v_dot2_f32_bf16 v146, v137, v105, v146
    v_dot2_f32_bf16 v146, v138, v106, v146
    v_dot2_f32_bf16 v146, v139, v107, v146
    v_dot2_f32_bf16 v146, v140, v108, v146
    v_dot2_f32_bf16 v146, v141, v109, v146
    v_dot2_f32_bf16 v146, v142, v110, v146
    v_dot2_f32_bf16 v146, v143, v111, v146
    s_nop 3
    v_add_f32_dpp v146, v146, v146 quad_perm:[1,0,3,2] row_mask:0xf bank_mask:0xf
    s_nop 1
    v_add_f32_dpp v146, v146, v146 quad_perm:[2,3,0,1] row_mask:0xf bank_mask:0xf
    v_cvt_pk_bf16_f32 v146, v146, v146
    v_and_b32 v146, 0xffff0000, v146
    v_mul_f32 v146, 0xbfb8aa3b, v146
    v_exp_f32 v146, v146
    s_nop 0
    v_add_f32 v146, 1.0, v146
    v_rcp_f32 v146, v146
    s_nop 0
    v_cvt_pk_bf16_f32 v146, v146, v146
    v_and_b32 v146, 0xffff0000, v146
    s_lshl_b32 s63, s61, 8
    s_lshl_b32 s64, s60, 13
    s_add_u32 s63, s63, s64
    s_add_u32 s63, s63, 8388608
    buffer_store_dword v146, v149, s[36:39], s63 offen sc1
    s_setprio 3
    s_barrier
L_common:
    s_and_b32 s80, s62, 3
    s_lshr_b32 s81, s62, 2
    v_mov_b32 v5, 69632
    ds_read_b64 v[12:13], v5
    s_lshl_b32 s63, s80, 11
    s_add_u32 s63, s63, 114688
    v_add_u32 v5, s63, v2
    ds_read_b128 v[180:183], v5
    ds_read_b128 v[184:187], v5 offset:1024
    ds_read_b128 v[172:175], v5 offset:8192
    ds_read_b128 v[176:179], v5 offset:9216
    s_and_b32 s63, s80, 2
    s_mul_i32 s63, s63, 6144
    s_and_b32 s64, s80, 1
    s_lshl_b32 s65, s81, 1
    s_add_u32 s64, s64, s65
    s_lshl_b32 s64, s64, 10
    s_add_u32 s63, s63, 90112
    v_add_u32 v6, s63, v2
    v_add_u32 v7, s64, v6
    ds_read_b128 v[36:39], v7
    ds_read_b128 v[40:43], v7 offset:6144
    ds_read_b128 v[44:47], v6 offset:4096
    ds_read_b128 v[48:51], v6 offset:5120
    ds_read_b128 v[52:55], v6 offset:10240
    ds_read_b128 v[56:59], v6 offset:11264
    v_and_b32 v6, 15, v1
    v_lshlrev_b32 v6, 3, v6
    v_lshrrev_b32 v7, 5, v1
    v_lshl_add_u32 v6, v7, 7, v6
    s_lshl_b32 s63, s80, 9
    s_add_u32 s63, s63, 66560
    v_add_u32 v6, s63, v6
    ds_read_b64_tr_b16 v[20:21], v6
    ds_read_b64_tr_b16 v[22:23], v6 offset:256
    s_mov_b32 s26, 0x0000ffff
    s_mov_b32 s27, 0x0000ffff
    v_and_b32 v244, 248, v16
    s_lshl_b32 s73, s60, 8
    s_add_u32 s73, s73, 8454144
    s_waitcnt lgkmcnt(0)
    v_mfma_f32_32x32x16_bf16 v[76:91], v[20:23], v[36:39], 0
    v_mfma_f32_32x32x16_bf16 v[92:107], v[20:23], v[40:43], 0
    v_mov_b32 v4, 0x3f803f80
    v_and_b32 v5, 27, v1
    v_cmp_eq_u32 vcc, 16, v5
    s_nop 1
    v_cndmask_b32 v4, 0, v4, vcc
    v_mov_b32 v204, v4
    v_mov_b32 v220, v4
    v_mov_b32 v205, v4
    v_mov_b32 v221, v4
    v_mov_b32 v206, v4
    v_mov_b32 v222, v4
    v_mov_b32 v207, v4
    v_mov_b32 v223, v4
    v_mov_b32 v208, v4
    v_mov_b32 v224, v4
    v_mov_b32 v209, v4
    v_mov_b32 v225, v4
    v_mov_b32 v210, v4
    v_mov_b32 v226, v4
    v_mov_b32 v211, v4
    v_mov_b32 v227, v4
    v_mov_b32 v212, v4
    v_mov_b32 v228, v4
    v_mov_b32 v213, v4
    v_mov_b32 v229, v4
    v_mov_b32 v214, v4
    v_mov_b32 v230, v4
    v_mov_b32 v215, v4
    v_mov_b32 v231, v4
    v_mov_b32 v216, v4
    v_mov_b32 v232, v4
    v_mov_b32 v217, v4
    v_mov_b32 v233, v4
    v_mov_b32 v218, v4
    v_mov_b32 v234, v4
    v_mov_b32 v219, v4
    v_mov_b32 v235, v4
    v_lshrrev_b32 v5, 5, v1
    v_and_b32 v6, 15, v1
    v_lshl_add_u32 v7, v5, 4, v6
    v_add_u32 v5, 32, v5
    v_cndmask_b32 v246, v5, v7, s[76:77]
    v_lshlrev_b32 v246, 2, v246
    v_lshlrev_b32 v6, 26, v6
    v_cndmask_b32 v6, v6, 0, s[76:77]
    v_add_u32 v248, v246, v6
    s_lshl_b32 s63, s60, 2
    s_add_u32 s63, s63, s80
    s_lshl_b32 s82, s63, 16
    s_lshl_b32 s63, s81, 15
    s_add_u32 s82, s82, s63
    s_add_u32 s83, s82, 2097152
    s_and_b32 s87, s61, 7
    v_lshrrev_b32 v4, 3, v1
    v_and_b32 v5, 7, v1
    v_bfe_u32 v6, v1, 4, 1
    v_lshlrev_b32 v6, 2, v6
    v_xor_b32 v5, v5, v6
    v_lshlrev_b32 v5, 4, v5
    v_mul_u32_u24 v245, 1024, v4
    v_add_u32 v245, v245, v5
    s_waitcnt vmcnt(0)
    s_barrier
    buffer_load_dwordx2 v[14:15], v244, s[36:39], s73 offen sc1
    v_cvt_pk_bf16_f32 v140, v76, v77
    v_cvt_pk_bf16_f32 v141, v78, v79
    v_cvt_pk_bf16_f32 v142, v80, v81
    v_cvt_pk_bf16_f32 v143, v82, v83
    v_lshlrev_b32 v76, 16, v140
    v_and_b32 v77, 0xffff0000, v140
    v_lshlrev_b32 v78, 16, v141
    v_and_b32 v79, 0xffff0000, v141
    v_lshlrev_b32 v80, 16, v142
    v_and_b32 v81, 0xffff0000, v142
    v_lshlrev_b32 v82, 16, v143
    v_and_b32 v83, 0xffff0000, v143
    v_max3_f32 v144, v76, v77, v78
    v_min3_f32 v145, v76, v77, v78
    v_max3_f32 v144, v144, v79, v80
    v_min3_f32 v145, v145, v79, v80
    v_max3_f32 v144, v144, v81, v82
    v_min3_f32 v145, v145, v81, v82
    v_max_f32 v144, v144, v83
    v_min_f32 v145, v145, v83
    v_mov_b32 v146, v144
    v_mov_b32 v147, v145
    s_nop 0
    v_permlane32_swap_b32 v144, v146
    v_permlane32_swap_b32 v145, v147
    v_max_f32 v144, v144, v146
    v_min_f32 v145, v145, v147
    v_mul_f32 v144, 0xbfb8aa3b, v144
    v_mul_f32 v145, 0x3fb8aa3b, v145
    v_fma_f32 v148, -v76, s67, v145
    v_fma_f32 v76, v76, s67, v144
    v_fma_f32 v149, -v77, s67, v145
    v_fma_f32 v77, v77, s67, v144
    v_fma_f32 v150, -v78, s67, v145
    v_fma_f32 v78, v78, s67, v144
    v_fma_f32 v151, -v79, s67, v145
    v_fma_f32 v79, v79, s67, v144
    v_fma_f32 v152, -v80, s67, v145
    v_fma_f32 v80, v80, s67, v144
    v_fma_f32 v153, -v81, s67, v145
    v_fma_f32 v81, v81, s67, v144
    v_fma_f32 v154, -v82, s67, v145
    v_fma_f32 v82, v82, s67, v144
    v_fma_f32 v155, -v83, s67, v145
    v_fma_f32 v83, v83, s67, v144
    v_exp_f32 v76, v76
    v_exp_f32 v148, v148
    v_exp_f32 v77, v77
    v_exp_f32 v149, v149
    v_exp_f32 v78, v78
    v_exp_f32 v150, v150
    v_exp_f32 v79, v79
    v_exp_f32 v151, v151
    v_exp_f32 v80, v80
    v_exp_f32 v152, v152
    v_exp_f32 v81, v81
    v_exp_f32 v153, v153
    v_exp_f32 v82, v82
    v_exp_f32 v154, v154
    v_exp_f32 v83, v83
    v_exp_f32 v155, v155
    v_add_f32 v144, v76, v77
    v_add_f32 v145, v148, v149
    v_add_f32 v146, v78, v79
    v_add_f32 v147, v150, v151
    v_add_f32 v144, v144, v146
    v_add_f32 v145, v145, v147
    v_add_f32 v146, v80, v81
    v_add_f32 v147, v152, v153
    v_add_f32 v144, v144, v146
    v_add_f32 v145, v145, v147
    v_add_f32 v146, v82, v83
    v_add_f32 v147, v154, v155
    v_add_f32 v144, v144, v146
    v_add_f32 v145, v145, v147
    v_mov_b32 v146, v144
    v_mov_b32 v147, v145
    s_nop 0
    v_permlane32_swap_b32 v144, v146
    v_permlane32_swap_b32 v145, v147
    v_add_f32 v144, v144, v146
    v_add_f32 v145, v145, v147
    v_rcp_f32 v144, v144
    v_rcp_f32 v145, v145
    v_mul_f32 v76, v76, v144
    v_mul_f32 v148, v148, v145
    v_mul_f32 v77, v77, v144
    v_mul_f32 v149, v149, v145
    v_mul_f32 v78, v78, v144
    v_mul_f32 v150, v150, v145
    v_mul_f32 v79, v79, v144
    v_mul_f32 v151, v151, v145
    v_mul_f32 v80, v80, v144
    v_mul_f32 v152, v152, v145
    v_mul_f32 v81, v81, v144
    v_mul_f32 v153, v153, v145
    v_mul_f32 v82, v82, v144
    v_mul_f32 v154, v154, v145
    v_mul_f32 v83, v83, v144
    v_mul_f32 v155, v155, v145
    v_cvt_pk_bf16_f32 v60, v76, v77
    v_cvt_pk_bf16_f32 v64, v148, v149
    v_cvt_pk_bf16_f32 v61, v78, v79
    v_cvt_pk_bf16_f32 v65, v150, v151
    v_cvt_pk_bf16_f32 v62, v80, v81
    v_cvt_pk_bf16_f32 v66, v152, v153
    v_cvt_pk_bf16_f32 v63, v82, v83
    v_cvt_pk_bf16_f32 v67, v154, v155
    s_mov_b32 s66, 0
L_sp1:
    s_waitcnt vmcnt(0)
    v_cmp_eq_u64 vcc, v[14:15], v[12:13]
    s_nop 0
    s_cmp_eq_u64 vcc, -1
    s_cbranch_scc1 L_sp1_ok
    s_sleep 4
    buffer_load_dwordx2 v[14:15], v244, s[36:39], s73 offen sc1
    s_add_u32 s66, s66, 1
    s_cmp_lt_u32 s66, 262144
    s_cbranch_scc1 L_sp1
L_sp1_ok:
    s_lshl_b32 s63, s87, 12
    s_add_u32 s64, s63, s82
    s_add_u32 s65, s63, s83
    buffer_load_dwordx4 v[188:191], v2, s[36:39], s64 offen offset:0 sc1
    buffer_load_dwordx4 v[192:195], v2, s[36:39], s64 offen offset:1024 sc1
    s_mov_b64 exec, s[26:27]
    buffer_load_dwordx4 v[204:207], v17, s[36:39], s65 offen offset:0 sc1
    buffer_load_dwordx4 v[220:223], v17, s[36:39], s65 offen offset:512 sc1
    s_mov_b64 exec, -1
    buffer_load_dwordx4 v[196:199], v2, s[36:39], s64 offen offset:2048 sc1
    s_mov_b64 exec, s[26:27]
    buffer_load_dwordx4 v[208:211], v17, s[36:39], s65 offen offset:1024 sc1
    buffer_load_dwordx4 v[224:227], v17, s[36:39], s65 offen offset:1536 sc1
    s_mov_b64 exec, -1
    buffer_load_dwordx4 v[200:203], v2, s[36:39], s64 offen offset:3072 sc1
    s_mov_b64 exec, s[26:27]
    buffer_load_dwordx4 v[212:215], v17, s[36:39], s65 offen offset:2048 sc1
    buffer_load_dwordx4 v[228:231], v17, s[36:39], s65 offen offset:2560 sc1
    s_mov_b64 exec, -1
    v_cvt_pk_bf16_f32 v140, v92, v93
    v_cvt_pk_bf16_f32 v141, v94, v95
    v_cvt_pk_bf16_f32 v142, v96, v97
    v_cvt_pk_bf16_f32 v143, v98, v99
    v_lshlrev_b32 v92, 16, v140
    v_and_b32 v93, 0xffff0000, v140
    v_lshlrev_b32 v94, 16, v141
    v_and_b32 v95, 0xffff0000, v141
    v_lshlrev_b32 v96, 16, v142
    v_and_b32 v97, 0xffff0000, v142
    v_lshlrev_b32 v98, 16, v143
    v_and_b32 v99, 0xffff0000, v143
    v_max3_f32 v144, v92, v93, v94
    v_min3_f32 v145, v92, v93, v94
    v_max3_f32 v144, v144, v95, v96
    v_min3_f32 v145, v145, v95, v96
    v_max3_f32 v144, v144, v97, v98
    v_min3_f32 v145, v145, v97, v98
    v_max_f32 v144, v144, v99
    v_min_f32 v145, v145, v99
    v_mov_b32 v146, v144
    v_mov_b32 v147, v145
    s_nop 0
    v_permlane32_swap_b32 v144, v146
    v_permlane32_swap_b32 v145, v147
    v_max_f32 v144, v144, v146
    v_min_f32 v145, v145, v147
    v_mul_f32 v144, 0xbfb8aa3b, v144
    v_mul_f32 v145, 0x3fb8aa3b, v145
    v_fma_f32 v148, -v92, s67, v145
    v_fma_f32 v92, v92, s67, v144
    v_fma_f32 v149, -v93, s67, v145
    v_fma_f32 v93, v93, s67, v144
    v_fma_f32 v150, -v94, s67, v145
    v_fma_f32 v94, v94, s67, v144
    v_fma_f32 v151, -v95, s67, v145
    v_fma_f32 v95, v95, s67, v144
    v_fma_f32 v152, -v96, s67, v145
    v_fma_f32 v96, v96, s67, v144
    v_fma_f32 v153, -v97, s67, v145
    v_fma_f32 v97, v97, s67, v144
    v_fma_f32 v154, -v98, s67, v145
    v_fma_f32 v98, v98, s67, v144
    v_fma_f32 v155, -v99, s67, v145
    v_fma_f32 v99, v99, s67, v144
    v_exp_f32 v92, v92
    v_exp_f32 v148, v148
    v_exp_f32 v93, v93
    v_exp_f32 v149, v149
    v_exp_f32 v94, v94
    v_exp_f32 v150, v150
    v_exp_f32 v95, v95
    v_exp_f32 v151, v151
    v_exp_f32 v96, v96
    v_exp_f32 v152, v152
    v_exp_f32 v97, v97
    v_exp_f32 v153, v153
    v_exp_f32 v98, v98
    v_exp_f32 v154, v154
    v_exp_f32 v99, v99
    v_exp_f32 v155, v155
    v_add_f32 v144, v92, v93
    v_add_f32 v145, v148, v149
    v_add_f32 v146, v94, v95
    v_add_f32 v147, v150, v151
    v_add_f32 v144, v144, v146
    v_add_f32 v145, v145, v147
    v_add_f32 v146, v96, v97
    v_add_f32 v147, v152, v153
    v_add_f32 v144, v144, v146
    v_add_f32 v145, v145, v147
    v_add_f32 v146, v98, v99
    v_add_f32 v147, v154, v155
    v_add_f32 v144, v144, v146
    v_add_f32 v145, v145, v147
    v_mov_b32 v146, v144
    v_mov_b32 v147, v145
    s_nop 0
    v_permlane32_swap_b32 v144, v146
    v_permlane32_swap_b32 v145, v147
    v_add_f32 v144, v144, v146
    v_add_f32 v145, v145, v147
    v_rcp_f32 v144, v144
    v_rcp_f32 v145, v145
    v_mul_f32 v92, v92, v144
    v_mul_f32 v148, v148, v145
    v_mul_f32 v93, v93, v144
    v_mul_f32 v149, v149, v145
    v_mul_f32 v94, v94, v144
    v_mul_f32 v150, v150, v145
    v_mul_f32 v95, v95, v144
    v_mul_f32 v151, v151, v145
    v_mul_f32 v96, v96, v144
    v_mul_f32 v152, v152, v145
    v_mul_f32 v97, v97, v144
    v_mul_f32 v153, v153, v145
    v_mul_f32 v98, v98, v144
    v_mul_f32 v154, v154, v145
    v_mul_f32 v99, v99, v144
    v_mul_f32 v155, v155, v145
    v_cvt_pk_bf16_f32 v68, v92, v93
    v_cvt_pk_bf16_f32 v72, v148, v149
    v_cvt_pk_bf16_f32 v69, v94, v95
    v_cvt_pk_bf16_f32 v73, v150, v151
    v_cvt_pk_bf16_f32 v70, v96, v97
    v_cvt_pk_bf16_f32 v74, v152, v153
    v_cvt_pk_bf16_f32 v71, v98, v99
    v_cvt_pk_bf16_f32 v75, v154, v155
    s_cmp_lt_u32 s62, 4
    s_cbranch_scc1 L_qwave
    v_mov_b32 v4, 0x3f803f80
    v_mfma_f32_32x32x16_bf16 v[76:91], v[60:63], v[28:31], 0
    v_mfma_f32_32x32x16_bf16 v[76:91], v[64:67], v[32:35], v[76:91]
    v_mfma_f32_32x32x16_bf16 v[92:107], v[68:71], v[28:31], 0
    v_mfma_f32_32x32x16_bf16 v[92:107], v[72:75], v[32:35], v[92:107]
    v_cndmask_b32 v44, v4, v44, s[76:77]
    v_cndmask_b32 v45, v4, v45, s[76:77]
    v_cndmask_b32 v46, v4, v46, s[76:77]
    v_cndmask_b32 v47, v4, v47, s[76:77]
    v_cndmask_b32 v48, v4, v48, s[76:77]
    v_cndmask_b32 v49, v4, v49, s[76:77]
    v_cndmask_b32 v50, v4, v50, s[76:77]
    v_cndmask_b32 v51, v4, v51, s[76:77]
    v_cndmask_b32 v52, v4, v52, s[76:77]
    v_cndmask_b32 v53, v4, v53, s[76:77]
    v_cndmask_b32 v54, v4, v54, s[76:77]
    v_cndmask_b32 v55, v4, v55, s[76:77]
    v_cndmask_b32 v56, v4, v56, s[76:77]
    v_cndmask_b32 v57, v4, v57, s[76:77]
    v_cndmask_b32 v58, v4, v58, s[76:77]
    v_cndmask_b32 v59, v4, v59, s[76:77]
    v_cvt_pk_bf16_f32 v124, v76, v77
    v_cvt_pk_bf16_f32 v125, v78, v79
    v_cvt_pk_bf16_f32 v126, v80, v81
    v_cvt_pk_bf16_f32 v127, v82, v83
    v_cvt_pk_bf16_f32 v128, v84, v85
    v_cvt_pk_bf16_f32 v129, v86, v87
    v_cvt_pk_bf16_f32 v130, v88, v89
    v_cvt_pk_bf16_f32 v131, v90, v91
    v_cvt_pk_bf16_f32 v132, v92, v93
    v_cvt_pk_bf16_f32 v133, v94, v95
    v_cvt_pk_bf16_f32 v134, v96, v97
    v_cvt_pk_bf16_f32 v135, v98, v99
    v_cvt_pk_bf16_f32 v136, v100, v101
    v_cvt_pk_bf16_f32 v137, v102, v103
    v_cvt_pk_bf16_f32 v138, v104, v105
    v_cvt_pk_bf16_f32 v139, v106, v107
    v_mfma_f32_32x32x16_bf16 v[108:123], v[124:127], v[44:47], 0
    v_mfma_f32_32x32x16_bf16 v[108:123], v[128:131], v[48:51], v[108:123]
    v_mfma_f32_32x32x16_bf16 v[108:123], v[132:135], v[52:55], v[108:123]
    v_mfma_f32_32x32x16_bf16 v[108:123], v[136:139], v[56:59], v[108:123]
    s_lshl_b32 s63, s71, 12
    s_add_u32 s63, s63, 9437184
    s_nop 9
    buffer_atomic_add_f32 v108, v248, s[36:39], s63 offen offset:0
    buffer_atomic_add_f32 v109, v248, s[36:39], s63 offen offset:256
    buffer_atomic_add_f32 v110, v248, s[36:39], s63 offen offset:512
    buffer_atomic_add_f32 v111, v248, s[36:39], s63 offen offset:768
    buffer_atomic_add_f32 v112, v248, s[36:39], s63 offen offset:1024
    buffer_atomic_add_f32 v113, v248, s[36:39], s63 offen offset:1280
    buffer_atomic_add_f32 v114, v248, s[36:39], s63 offen offset:1536
    buffer_atomic_add_f32 v115, v248, s[36:39], s63 offen offset:1792
    buffer_atomic_add_f32 v116, v248, s[36:39], s63 offen offset:2048
    buffer_atomic_add_f32 v117, v248, s[36:39], s63 offen offset:2304
    buffer_atomic_add_f32 v118, v248, s[36:39], s63 offen offset:2560
    buffer_atomic_add_f32 v119, v248, s[36:39], s63 offen offset:2816
    buffer_atomic_add_f32 v120, v248, s[36:39], s63 offen offset:3072
    buffer_atomic_add_f32 v121, v248, s[36:39], s63 offen offset:3328
    buffer_atomic_add_f32 v122, v248, s[36:39], s63 offen offset:3584
    buffer_atomic_add_f32 v123, v248, s[36:39], s63 offen offset:3840
L_qwave:
    v_mfma_f32_32x32x16_bf16 v[140:155], v[172:175], v[180:183], 0
    v_mfma_f32_32x32x16_bf16 v[156:171], v[176:179], v[184:187], 0
    s_bfe_u32 s59, s2, 0x30003
    s_mov_b32 s32, s10
    s_and_b32 s33, s11, 0xffff
    s_mov_b32 s34, 524288
    s_mov_b32 s35, 0x00020000
    s_mov_b32 s44, s16
    s_and_b32 s45, s17, 0xffff
    s_mov_b32 s46, 524288
    s_mov_b32 s47, 0x00020000
    v_mov_b32 v176, 0
    v_mov_b32 v177, 0
    v_mov_b32 v178, 0
    v_mov_b32 v179, 0
    v_mov_b32 v138, 0
    v_mov_b32 v139, 0
    v_max3_f32 v4, v140, v141, v142
    v_max3_f32 v4, v4, v143, v144
    v_max3_f32 v4, v4, v145, v146
    v_max3_f32 v4, v4, v147, v148
    v_max3_f32 v4, v4, v149, v150
    v_max3_f32 v4, v4, v151, v152
    v_max3_f32 v4, v4, v153, v154
    v_max_f32 v4, v4, v155
    v_max3_f32 v5, v156, v157, v158
    v_max3_f32 v5, v5, v159, v160
    v_max3_f32 v5, v5, v161, v162
    v_max3_f32 v5, v5, v163, v164
    v_max3_f32 v5, v5, v165, v166
    v_max3_f32 v5, v5, v167, v168
    v_max3_f32 v5, v5, v169, v170
    v_max_f32 v5, v5, v171
    v_mov_b32 v7, v4
    s_nop 1
    v_permlane32_swap_b32 v4, v7
    v_max_f32 v4, v4, v7
    v_sub_f32 v76, 0, v4
    v_mov_b32 v77, v76
    v_mov_b32 v78, v76
    v_mov_b32 v79, v76
    v_mov_b32 v80, v76
    v_mov_b32 v81, v76
    v_mov_b32 v82, v76
    v_mov_b32 v83, v76
    v_mov_b32 v84, v76
    v_mov_b32 v85, v76
    v_mov_b32 v86, v76
    v_mov_b32 v87, v76
    v_mov_b32 v88, v76
    v_mov_b32 v89, v76
    v_mov_b32 v90, v76
    v_mov_b32 v91, v76
    v_mov_b32 v7, v5
    s_nop 1
    v_permlane32_swap_b32 v5, v7
    v_max_f32 v5, v5, v7
    v_sub_f32 v92, 0, v5
    v_mov_b32 v93, v92
    v_mov_b32 v94, v92
    v_mov_b32 v95, v92
    v_mov_b32 v96, v92
    v_mov_b32 v97, v92
    v_mov_b32 v98, v92
    v_mov_b32 v99, v92
    v_mov_b32 v100, v92
    v_mov_b32 v101, v92
    v_mov_b32 v102, v92
    v_mov_b32 v103, v92
    v_mov_b32 v104, v92
    v_mov_b32 v105, v92
    v_mov_b32 v106, v92
    v_mov_b32 v107, v92
    v_mfma_f32_32x32x16_bf16 v[140:155], v[176:179], v[176:179], 0
    v_mfma_f32_32x32x16_bf16 v[156:171], v[176:179], v[176:179], 0
    s_cmp_lt_u32 s62, 4
    s_cbranch_scc1 L_w9
    s_waitcnt vmcnt(25)
    s_branch L_w9b
L_w9:
    s_waitcnt vmcnt(9)
L_w9b:
    s_cmp_lt_u32 s62, 4
    s_cselect_b32 s86, 0, 4
    s_cmp_lt_u32 s62, 4
    s_setprio 2
    s_cbranch_scc1 L_pq
    s_setprio 3
L_pq:
    s_mov_b32 s85, 0
    v_mfma_f32_32x32x16_bf16 v[108:123], v[188:191], v[180:183], v[76:91]
    s_nop 7
    s_nop 3
L_loop:
    s_lshl_b32 s63, s87, 12
    s_add_u32 s57, s63, s83
    s_add_u32 s87, s87, 1
    s_and_b32 s87, s87, 7
    s_lshl_b32 s63, s87, 12
    s_add_u32 s56, s63, s82
    s_add_u32 s58, s63, s83
    v_exp_f32 v108, v108
    v_cvt_pk_bf16_f32 v179, v138, v139
    v_exp_f32 v109, v109
    v_mfma_f32_32x32x16_bf16 v[124:139], v[188:191], v[184:187], v[92:107]
    buffer_load_dwordx4 v[188:191], v2, s[36:39], s56 offen offset:0 sc1
    v_exp_f32 v110, v110
    v_exp_f32 v111, v111
    v_cvt_pk_bf16_f32 v172, v108, v109
    v_exp_f32 v112, v112
    v_exp_f32 v113, v113
    v_cvt_pk_bf16_f32 v173, v110, v111
    v_mfma_f32_32x32x16_bf16 v[156:171], v[232:235], v[176:179], v[156:171]
    s_mov_b64 exec, s[26:27]
    buffer_load_dwordx4 v[216:219], v17, s[36:39], s57 offen offset:3072 sc1
    buffer_load_dwordx4 v[232:235], v17, s[36:39], s57 offen offset:3584 sc1
    s_mov_b64 exec, -1
    v_exp_f32 v114, v114
    v_exp_f32 v115, v115
    v_cvt_pk_bf16_f32 v174, v112, v113
    v_exp_f32 v116, v116
    v_exp_f32 v117, v117
    v_cvt_pk_bf16_f32 v175, v114, v115
    v_exp_f32 v118, v118
    v_exp_f32 v119, v119
    s_waitcnt vmcnt(9)
    v_mfma_f32_32x32x16_bf16 v[140:155], v[204:207], v[172:175], v[140:155]
    v_cvt_pk_bf16_f32 v176, v116, v117
    v_exp_f32 v120, v120
    v_exp_f32 v121, v121
    v_cvt_pk_bf16_f32 v177, v118, v119
    v_exp_f32 v122, v122
    v_exp_f32 v123, v123
    v_cvt_pk_bf16_f32 v178, v120, v121
    v_exp_f32 v124, v124
    v_cvt_pk_bf16_f32 v179, v122, v123
    v_exp_f32 v125, v125
    v_mfma_f32_32x32x16_bf16 v[108:123], v[192:195], v[180:183], v[76:91]
    v_exp_f32 v126, v126
    v_exp_f32 v127, v127
    v_cvt_pk_bf16_f32 v172, v124, v125
    v_exp_f32 v128, v128
    v_exp_f32 v129, v129
    v_cvt_pk_bf16_f32 v173, v126, v127
    v_mfma_f32_32x32x16_bf16 v[140:155], v[220:223], v[176:179], v[140:155]
    v_exp_f32 v130, v130
    v_exp_f32 v131, v131
    v_cvt_pk_bf16_f32 v174, v128, v129
    v_exp_f32 v132, v132
    v_exp_f32 v133, v133
    v_cvt_pk_bf16_f32 v175, v130, v131
    v_exp_f32 v134, v134
    v_exp_f32 v135, v135
    v_mfma_f32_32x32x16_bf16 v[156:171], v[204:207], v[172:175], v[156:171]
    v_cvt_pk_bf16_f32 v176, v132, v133
    v_exp_f32 v136, v136
    v_exp_f32 v137, v137
    v_cvt_pk_bf16_f32 v177, v134, v135
    v_exp_f32 v138, v138
    v_exp_f32 v139, v139
    v_cvt_pk_bf16_f32 v178, v136, v137
    v_exp_f32 v108, v108
    v_cvt_pk_bf16_f32 v179, v138, v139
    v_exp_f32 v109, v109
    v_mfma_f32_32x32x16_bf16 v[124:139], v[192:195], v[184:187], v[92:107]
    buffer_load_dwordx4 v[192:195], v2, s[36:39], s56 offen offset:1024 sc1
    v_exp_f32 v110, v110
    v_exp_f32 v111, v111
    v_cvt_pk_bf16_f32 v172, v108, v109
    v_exp_f32 v112, v112
    v_exp_f32 v113, v113
    v_cvt_pk_bf16_f32 v173, v110, v111
    v_mfma_f32_32x32x16_bf16 v[156:171], v[220:223], v[176:179], v[156:171]
    s_mov_b64 exec, s[26:27]
    buffer_load_dwordx4 v[204:207], v17, s[36:39], s58 offen offset:0 sc1
    buffer_load_dwordx4 v[220:223], v17, s[36:39], s58 offen offset:512 sc1
    s_mov_b64 exec, -1
    v_exp_f32 v114, v114
    v_exp_f32 v115, v115
    v_cvt_pk_bf16_f32 v174, v112, v113
    v_exp_f32 v116, v116
    v_exp_f32 v117, v117
    v_cvt_pk_bf16_f32 v175, v114, v115
    v_exp_f32 v118, v118
    v_exp_f32 v119, v119
    s_waitcnt vmcnt(9)
    v_mfma_f32_32x32x16_bf16 v[140:155], v[208:211], v[172:175], v[140:155]
    v_cvt_pk_bf16_f32 v176, v116, v117
    v_exp_f32 v120, v120
    v_exp_f32 v121, v121
    v_cvt_pk_bf16_f32 v177, v118, v119
    v_exp_f32 v122, v122
    v_exp_f32 v123, v123
    v_cvt_pk_bf16_f32 v178, v120, v121
    v_exp_f32 v124, v124
    v_cvt_pk_bf16_f32 v179, v122, v123
    v_exp_f32 v125, v125
    v_mfma_f32_32x32x16_bf16 v[108:123], v[196:199], v[180:183], v[76:91]
    v_exp_f32 v126, v126
    v_exp_f32 v127, v127
    v_cvt_pk_bf16_f32 v172, v124, v125
    v_exp_f32 v128, v128
    v_exp_f32 v129, v129
    v_cvt_pk_bf16_f32 v173, v126, v127
    v_mfma_f32_32x32x16_bf16 v[140:155], v[224:227], v[176:179], v[140:155]
    v_exp_f32 v130, v130
    v_exp_f32 v131, v131
    v_cvt_pk_bf16_f32 v174, v128, v129
    v_exp_f32 v132, v132
    v_exp_f32 v133, v133
    v_cvt_pk_bf16_f32 v175, v130, v131
    v_exp_f32 v134, v134
    v_exp_f32 v135, v135
    v_mfma_f32_32x32x16_bf16 v[156:171], v[208:211], v[172:175], v[156:171]
    v_cvt_pk_bf16_f32 v176, v132, v133
    v_exp_f32 v136, v136
    v_exp_f32 v137, v137
    v_cvt_pk_bf16_f32 v177, v134, v135
    v_exp_f32 v138, v138
    v_exp_f32 v139, v139
    v_cvt_pk_bf16_f32 v178, v136, v137
    v_exp_f32 v108, v108
    v_cvt_pk_bf16_f32 v179, v138, v139
    v_exp_f32 v109, v109
    v_mfma_f32_32x32x16_bf16 v[124:139], v[196:199], v[184:187], v[92:107]
    buffer_load_dwordx4 v[196:199], v2, s[36:39], s56 offen offset:2048 sc1
    v_exp_f32 v110, v110
    v_exp_f32 v111, v111
    v_cvt_pk_bf16_f32 v172, v108, v109
    v_exp_f32 v112, v112
    v_exp_f32 v113, v113
    v_cvt_pk_bf16_f32 v173, v110, v111
    v_mfma_f32_32x32x16_bf16 v[156:171], v[224:227], v[176:179], v[156:171]
    s_mov_b64 exec, s[26:27]
    buffer_load_dwordx4 v[208:211], v17, s[36:39], s58 offen offset:1024 sc1
    buffer_load_dwordx4 v[224:227], v17, s[36:39], s58 offen offset:1536 sc1
    s_mov_b64 exec, -1
    v_exp_f32 v114, v114
    v_exp_f32 v115, v115
    v_cvt_pk_bf16_f32 v174, v112, v113
    v_exp_f32 v116, v116
    v_exp_f32 v117, v117
    v_cvt_pk_bf16_f32 v175, v114, v115
    v_exp_f32 v118, v118
    v_exp_f32 v119, v119
    s_waitcnt vmcnt(9)
    v_mfma_f32_32x32x16_bf16 v[140:155], v[212:215], v[172:175], v[140:155]
    v_cvt_pk_bf16_f32 v176, v116, v117
    v_exp_f32 v120, v120
    v_exp_f32 v121, v121
    v_cvt_pk_bf16_f32 v177, v118, v119
    v_exp_f32 v122, v122
    v_exp_f32 v123, v123
    v_cvt_pk_bf16_f32 v178, v120, v121
    v_exp_f32 v124, v124
    v_cvt_pk_bf16_f32 v179, v122, v123
    v_exp_f32 v125, v125
    v_mfma_f32_32x32x16_bf16 v[108:123], v[200:203], v[180:183], v[76:91]
    v_exp_f32 v126, v126
    v_exp_f32 v127, v127
    v_cvt_pk_bf16_f32 v172, v124, v125
    v_exp_f32 v128, v128
    v_exp_f32 v129, v129
    v_cvt_pk_bf16_f32 v173, v126, v127
    v_mfma_f32_32x32x16_bf16 v[140:155], v[228:231], v[176:179], v[140:155]
    v_exp_f32 v130, v130
    v_exp_f32 v131, v131
    v_cvt_pk_bf16_f32 v174, v128, v129
    v_exp_f32 v132, v132
    v_exp_f32 v133, v133
    v_cvt_pk_bf16_f32 v175, v130, v131
    v_exp_f32 v134, v134
    v_exp_f32 v135, v135
    v_mfma_f32_32x32x16_bf16 v[156:171], v[212:215], v[172:175], v[156:171]
    v_cvt_pk_bf16_f32 v176, v132, v133
    v_exp_f32 v136, v136
    v_exp_f32 v137, v137
    v_cvt_pk_bf16_f32 v177, v134, v135
    v_exp_f32 v138, v138
    v_exp_f32 v139, v139
    v_cvt_pk_bf16_f32 v178, v136, v137
    v_exp_f32 v108, v108
    v_cvt_pk_bf16_f32 v179, v138, v139
    v_exp_f32 v109, v109
    v_mfma_f32_32x32x16_bf16 v[124:139], v[200:203], v[184:187], v[92:107]
    buffer_load_dwordx4 v[200:203], v2, s[36:39], s56 offen offset:3072 sc1
    v_exp_f32 v110, v110
    v_exp_f32 v111, v111
    v_cvt_pk_bf16_f32 v172, v108, v109
    v_exp_f32 v112, v112
    v_exp_f32 v113, v113
    v_cvt_pk_bf16_f32 v173, v110, v111
    v_mfma_f32_32x32x16_bf16 v[156:171], v[228:231], v[176:179], v[156:171]
    s_mov_b64 exec, s[26:27]
    buffer_load_dwordx4 v[212:215], v17, s[36:39], s58 offen offset:2048 sc1
    buffer_load_dwordx4 v[228:231], v17, s[36:39], s58 offen offset:2560 sc1
    s_mov_b64 exec, -1
    v_exp_f32 v114, v114
    v_exp_f32 v115, v115
    v_cvt_pk_bf16_f32 v174, v112, v113
    v_exp_f32 v116, v116
    v_exp_f32 v117, v117
    v_cvt_pk_bf16_f32 v175, v114, v115
    v_exp_f32 v118, v118
    v_exp_f32 v119, v119
    s_waitcnt vmcnt(9)
    v_mfma_f32_32x32x16_bf16 v[140:155], v[216:219], v[172:175], v[140:155]
    v_cvt_pk_bf16_f32 v176, v116, v117
    v_exp_f32 v120, v120
    v_exp_f32 v121, v121
    v_cvt_pk_bf16_f32 v177, v118, v119
    v_exp_f32 v122, v122
    v_exp_f32 v123, v123
    v_cvt_pk_bf16_f32 v178, v120, v121
    v_exp_f32 v124, v124
    v_cvt_pk_bf16_f32 v179, v122, v123
    v_exp_f32 v125, v125
    v_mfma_f32_32x32x16_bf16 v[108:123], v[188:191], v[180:183], v[76:91]
    v_exp_f32 v126, v126
    v_exp_f32 v127, v127
    v_cvt_pk_bf16_f32 v172, v124, v125
    v_exp_f32 v128, v128
    v_exp_f32 v129, v129
    v_cvt_pk_bf16_f32 v173, v126, v127
    v_mfma_f32_32x32x16_bf16 v[140:155], v[232:235], v[176:179], v[140:155]
    v_exp_f32 v130, v130
    v_exp_f32 v131, v131
    v_cvt_pk_bf16_f32 v174, v128, v129
    v_exp_f32 v132, v132
    v_exp_f32 v133, v133
    v_cvt_pk_bf16_f32 v175, v130, v131
    v_exp_f32 v134, v134
    v_exp_f32 v135, v135
    v_mfma_f32_32x32x16_bf16 v[156:171], v[216:219], v[172:175], v[156:171]
    v_cvt_pk_bf16_f32 v176, v132, v133
    v_exp_f32 v136, v136
    v_exp_f32 v137, v137
    v_cvt_pk_bf16_f32 v177, v134, v135
    v_exp_f32 v138, v138
    v_exp_f32 v139, v139
    v_cvt_pk_bf16_f32 v178, v136, v137
    s_add_u32 s85, s85, 1
    s_cmp_eq_u32 s85, 1
    s_cbranch_scc1 L_h1
    s_cmp_eq_u32 s85, 2
    s_cbranch_scc1 L_h2
    s_cmp_eq_u32 s85, 3
    s_cbranch_scc1 L_h3
    s_cmp_eq_u32 s85, 4
    s_cbranch_scc1 L_h4
    s_cmp_eq_u32 s85, 5
    s_cbranch_scc1 L_h5
    s_cmp_eq_u32 s85, 6
    s_cbranch_scc1 L_h6
    s_cmp_eq_u32 s85, 7
    s_cbranch_scc1 L_h7
    s_branch L_loop_done
L_sm:
    s_cmp_eq_u32 s86, 0
    s_cbranch_scc1 L_sm0
    s_cmp_eq_u32 s86, 1
    s_cbranch_scc1 L_sm1
    s_cmp_eq_u32 s86, 2
    s_cbranch_scc1 L_sm2
    s_cmp_eq_u32 s86, 3
    s_cbranch_scc1 L_sm3
    s_cmp_eq_u32 s86, 4
    s_cbranch_scc1 L_sm4
    s_cmp_eq_u32 s86, 5
    s_cbranch_scc1 L_sm5
L_sm_out:
    s_cmp_lt_u32 s85, 8
    s_cbranch_scc1 L_loop
    s_cmp_eq_u32 s85, 9
    s_cbranch_scc1 L_sm_x
    s_branch L_sm_ret
L_sm0:
    s_lshl_b32 s73, s71, 8
    s_add_u32 s73, s73, 8470528
    buffer_load_dwordx2 v[14:15], v244, s[36:39], s73 offen sc1
    s_mov_b32 s86, 1
    s_branch L_sm_out
L_sm1:
    v_cmp_eq_u64 vcc, v[14:15], v[12:13]
    s_nop 0
    s_cmp_eq_u64 vcc, -1
    s_cbranch_scc0 L_sm0
    s_lshl_b32 s63, s71, 12
    s_add_u32 s63, s63, 9437184
    buffer_load_dword v36, v246, s[36:39], s63 offen offset:0 sc1
    buffer_load_dword v37, v246, s[36:39], s63 offen offset:256 sc1
    buffer_load_dword v38, v246, s[36:39], s63 offen offset:512 sc1
    buffer_load_dword v39, v246, s[36:39], s63 offen offset:768 sc1
    buffer_load_dword v40, v246, s[36:39], s63 offen offset:1024 sc1
    buffer_load_dword v41, v246, s[36:39], s63 offen offset:1280 sc1
    buffer_load_dword v42, v246, s[36:39], s63 offen offset:1536 sc1
    buffer_load_dword v43, v246, s[36:39], s63 offen offset:1792 sc1
    buffer_load_dword v44, v246, s[36:39], s63 offen offset:2048 sc1
    buffer_load_dword v45, v246, s[36:39], s63 offen offset:2304 sc1
    buffer_load_dword v46, v246, s[36:39], s63 offen offset:2560 sc1
    buffer_load_dword v47, v246, s[36:39], s63 offen offset:2816 sc1
    buffer_load_dword v48, v246, s[36:39], s63 offen offset:3072 sc1
    buffer_load_dword v49, v246, s[36:39], s63 offen offset:3328 sc1
    buffer_load_dword v50, v246, s[36:39], s63 offen offset:3584 sc1
    buffer_load_dword v51, v246, s[36:39], s63 offen offset:3840 sc1
    s_mov_b32 s86, 2
    s_branch L_sm_out
L_sm2:
    v_cvt_pk_bf16_f32 v236, v36, v37
    v_cvt_pk_bf16_f32 v237, v38, v39
    v_cvt_pk_bf16_f32 v238, v40, v41
    v_cvt_pk_bf16_f32 v239, v42, v43
    v_cvt_pk_bf16_f32 v240, v44, v45
    v_cvt_pk_bf16_f32 v241, v46, v47
    v_cvt_pk_bf16_f32 v242, v48, v49
    v_cvt_pk_bf16_f32 v243, v50, v51
    v_mfma_f32_32x32x16_bf16 v[20:35], v[236:239], v[60:63], 0
    s_nop 0
    v_mfma_f32_32x32x16_bf16 v[20:35], v[240:243], v[64:67], v[20:35]
    v_mfma_f32_32x32x16_bf16 v[36:51], v[236:239], v[68:71], 0
    v_mfma_f32_32x32x16_bf16 v[36:51], v[240:243], v[72:75], v[36:51]
    s_lshl_b32 s63, s61, 6
    s_add_u32 s63, s63, s71
    s_lshl_b32 s63, s63, 10
    s_add_u32 s63, s63, 4194304
    s_add_u32 s64, s63, 32768
    s_bitcmp1_b32 s62, 0
    s_cbranch_scc0 L_oa_even
    s_nop 2
    v_add_f32 v6, 0x358637bd, v20
    v_rcp_f32 v6, v6
    v_add_f32 v7, 0x358637bd, v36
    v_rcp_f32 v7, v7
    v_mul_f32 v20, v28, v6
    v_mul_f32 v21, v29, v6
    v_mul_f32 v22, v30, v6
    v_mul_f32 v23, v31, v6
    v_mul_f32 v24, v32, v6
    v_mul_f32 v25, v33, v6
    v_mul_f32 v26, v34, v6
    v_mul_f32 v27, v35, v6
    v_mul_f32 v36, v44, v7
    v_mul_f32 v37, v45, v7
    v_mul_f32 v38, v46, v7
    v_mul_f32 v39, v47, v7
    v_mul_f32 v40, v48, v7
    v_mul_f32 v41, v49, v7
    v_mul_f32 v42, v50, v7
    v_mul_f32 v43, v51, v7
    s_branch L_oa_j
L_oa_even:
    s_nop 2
    v_add_f32 v6, 0x358637bd, v28
    v_rcp_f32 v6, v6
    v_add_f32 v7, 0x358637bd, v44
    v_rcp_f32 v7, v7
    v_mul_f32 v20, v20, v6
    v_mul_f32 v21, v21, v6
    v_mul_f32 v22, v22, v6
    v_mul_f32 v23, v23, v6
    v_mul_f32 v24, v24, v6
    v_mul_f32 v25, v25, v6
    v_mul_f32 v26, v26, v6
    v_mul_f32 v27, v27, v6
    v_mul_f32 v36, v36, v7
    v_mul_f32 v37, v37, v7
    v_mul_f32 v38, v38, v7
    v_mul_f32 v39, v39, v7
    v_mul_f32 v40, v40, v7
    v_mul_f32 v41, v41, v7
    v_mul_f32 v42, v42, v7
    v_mul_f32 v43, v43, v7
L_oa_j:
    v_cvt_pk_bf16_f32 v236, v20, v21
    v_cvt_pk_bf16_f32 v237, v22, v23
    v_cvt_pk_bf16_f32 v238, v24, v25
    v_cvt_pk_bf16_f32 v239, v26, v27
    v_cvt_pk_bf16_f32 v240, v36, v37
    v_cvt_pk_bf16_f32 v241, v38, v39
    v_cvt_pk_bf16_f32 v242, v40, v41
    v_cvt_pk_bf16_f32 v243, v42, v43
    buffer_store_dwordx4 v[236:239], v2, s[36:39], s63 offen sc1
    buffer_store_dwordx4 v[240:243], v2, s[36:39], s64 offen sc1
    s_mov_b32 s86, 3
    s_branch L_sm_out
L_sm3:
    s_lshl_b32 s64, s61, 5
    s_add_u32 s64, s64, s71
    s_lshl_b32 s63, s64, 3
    s_add_u32 s63, s63, 8486912
    s_mov_b64 exec, 1
    buffer_store_dwordx2 v[12:13], v3, s[36:39], s63 offen sc1
    s_mov_b64 exec, -1
    s_mov_b32 s86, 4
    s_branch L_sm_out
L_sm4:
    s_cmp_lt_u32 s85, 6
    s_cbranch_scc1 L_loop
    v_and_b32 v244, 56, v16
    s_lshl_b32 s73, s3, 8
    s_lshl_b32 s63, s80, 6
    s_add_u32 s73, s73, s63
    s_add_u32 s73, s73, 8486912
    buffer_load_dwordx2 v[14:15], v244, s[36:39], s73 offen sc1
    s_mov_b32 s86, 5
    s_branch L_sm_out
L_sm5:
    v_cmp_eq_u64 vcc, v[14:15], v[12:13]
    s_nop 0
    s_cmp_eq_u64 vcc, -1
    s_cbranch_scc0 L_sm4
    s_lshl_b32 s63, s3, 16
    s_lshl_b32 s64, s81, 15
    s_add_u32 s63, s63, s64
    s_lshl_b32 s64, s80, 13
    s_add_u32 s63, s63, s64
    s_add_u32 s63, s63, 4194304
    s_add_u32 s64, s63, 4096
    buffer_load_dwordx4 v[36:39], v2, s[36:39], s63 offen offset:0 sc1
    buffer_load_dwordx4 v[40:43], v2, s[36:39], s63 offen offset:1024 sc1
    buffer_load_dwordx4 v[44:47], v2, s[36:39], s63 offen offset:2048 sc1
    buffer_load_dwordx4 v[48:51], v2, s[36:39], s63 offen offset:3072 sc1
    buffer_load_dwordx4 v[52:55], v2, s[36:39], s64 offen offset:0 sc1
    buffer_load_dwordx4 v[56:59], v2, s[36:39], s64 offen offset:1024 sc1
    buffer_load_dwordx4 v[60:63], v2, s[36:39], s64 offen offset:2048 sc1
    buffer_load_dwordx4 v[64:67], v2, s[36:39], s64 offen offset:3072 sc1
    v_and_b32 v246, 31, v1
    v_lshlrev_b32 v246, 2, v246
    s_lshl_b32 s63, s80, 14
    s_lshl_b32 s64, s3, 8
    s_add_u32 s63, s63, s64
    s_lshl_b32 s64, s81, 7
    s_add_u32 s63, s63, s64
    s_add_u32 s63, s63, 8388608
    buffer_load_dword v68, v246, s[36:39], s63 offen sc1
    s_mov_b32 s86, 6
    s_branch L_sm_out
L_h1:
    s_lshl_b32 s64, s62, 14
    s_add_u32 m0, s64, 0
    s_lshl_b32 s64, s62, 16
    s_lshl_b32 s65, s59, 7
    s_add_u32 s64, s64, s65
    s_add_u32 s64, s64, 0
    buffer_load_dwordx4 v245, s[32:35], s64 offen lds
    s_lshl_b32 s64, s62, 14
    s_add_u32 m0, s64, 1024
    s_lshl_b32 s64, s62, 16
    s_lshl_b32 s65, s59, 7
    s_add_u32 s64, s64, s65
    s_add_u32 s64, s64, 8192
    buffer_load_dwordx4 v245, s[32:35], s64 offen lds
    s_lshl_b32 s64, s62, 14
    s_add_u32 m0, s64, 2048
    s_lshl_b32 s64, s62, 16
    s_lshl_b32 s65, s59, 7
    s_add_u32 s64, s64, s65
    s_add_u32 s64, s64, 16384
    buffer_load_dwordx4 v245, s[32:35], s64 offen lds
    s_cmp_lt_u32 s62, 4
    s_cbranch_scc1 L_h1q
    s_lshl_b32 s64, s71, 5
    s_add_u32 s64, s64, s61
    s_lshl_b32 s63, s64, 3
    s_add_u32 s63, s63, 8470528
    s_mov_b64 exec, 1
    buffer_store_dwordx2 v[12:13], v3, s[36:39], s63 offen sc1
    s_mov_b64 exec, -1
    s_branch L_loop
L_h1q:
    s_branch L_sm
L_h2:
    s_lshl_b32 s64, s62, 14
    s_add_u32 m0, s64, 3072
    s_lshl_b32 s64, s62, 16
    s_lshl_b32 s65, s59, 7
    s_add_u32 s64, s64, s65
    s_add_u32 s64, s64, 24576
    buffer_load_dwordx4 v245, s[32:35], s64 offen lds
    s_lshl_b32 s64, s62, 14
    s_add_u32 m0, s64, 4096
    s_lshl_b32 s64, s62, 16
    s_lshl_b32 s65, s59, 7
    s_add_u32 s64, s64, s65
    s_add_u32 s64, s64, 32768
    buffer_load_dwordx4 v245, s[32:35], s64 offen lds
    s_lshl_b32 s64, s62, 14
    s_add_u32 m0, s64, 5120
    s_lshl_b32 s64, s62, 16
    s_lshl_b32 s65, s59, 7
    s_add_u32 s64, s64, s65
    s_add_u32 s64, s64, 40960
    buffer_load_dwordx4 v245, s[32:35], s64 offen lds
    s_cmp_lt_u32 s62, 4
    s_cbranch_scc1 L_h2q
    s_branch L_loop
L_h2q:
    s_branch L_sm
L_h3:
    s_lshl_b32 s64, s62, 14
    s_add_u32 m0, s64, 6144
    s_lshl_b32 s64, s62, 16
    s_lshl_b32 s65, s59, 7
    s_add_u32 s64, s64, s65
    s_add_u32 s64, s64, 49152
    buffer_load_dwordx4 v245, s[32:35], s64 offen lds
    s_lshl_b32 s64, s62, 14
    s_add_u32 m0, s64, 7168
    s_lshl_b32 s64, s62, 16
    s_lshl_b32 s65, s59, 7
    s_add_u32 s64, s64, s65
    s_add_u32 s64, s64, 57344
    buffer_load_dwordx4 v245, s[32:35], s64 offen lds
    s_lshl_b32 s64, s62, 14
    s_add_u32 m0, s64, 8192
    s_lshl_b32 s64, s62, 16
    s_lshl_b32 s65, s59, 7
    s_add_u32 s64, s64, s65
    s_add_u32 s64, s64, 0
    buffer_load_dwordx4 v245, s[44:47], s64 offen lds
    s_cmp_lt_u32 s62, 4
    s_cbranch_scc1 L_h3q
    s_branch L_loop
L_h3q:
    s_branch L_sm
L_h4:
    s_lshl_b32 s64, s62, 14
    s_add_u32 m0, s64, 9216
    s_lshl_b32 s64, s62, 16
    s_lshl_b32 s65, s59, 7
    s_add_u32 s64, s64, s65
    s_add_u32 s64, s64, 8192
    buffer_load_dwordx4 v245, s[44:47], s64 offen lds
    s_lshl_b32 s64, s62, 14
    s_add_u32 m0, s64, 10240
    s_lshl_b32 s64, s62, 16
    s_lshl_b32 s65, s59, 7
    s_add_u32 s64, s64, s65
    s_add_u32 s64, s64, 16384
    buffer_load_dwordx4 v245, s[44:47], s64 offen lds
    s_lshl_b32 s64, s62, 14
    s_add_u32 m0, s64, 11264
    s_lshl_b32 s64, s62, 16
    s_lshl_b32 s65, s59, 7
    s_add_u32 s64, s64, s65
    s_add_u32 s64, s64, 24576
    buffer_load_dwordx4 v245, s[44:47], s64 offen lds
    s_cmp_lt_u32 s62, 4
    s_cbranch_scc1 L_h4q
    s_setprio 2
    s_branch L_loop
L_h4q:
    s_setprio 1
    s_branch L_sm
L_h5:
    s_lshl_b32 s64, s62, 14
    s_add_u32 m0, s64, 12288
    s_lshl_b32 s64, s62, 16
    s_lshl_b32 s65, s59, 7
    s_add_u32 s64, s64, s65
    s_add_u32 s64, s64, 32768
    buffer_load_dwordx4 v245, s[44:47], s64 offen lds
    s_lshl_b32 s64, s62, 14
    s_add_u32 m0, s64, 13312
    s_lshl_b32 s64, s62, 16
    s_lshl_b32 s65, s59, 7
    s_add_u32 s64, s64, s65
    s_add_u32 s64, s64, 40960
    buffer_load_dwordx4 v245, s[44:47], s64 offen lds
    s_lshl_b32 s64, s62, 14
    s_add_u32 m0, s64, 14336
    s_lshl_b32 s64, s62, 16
    s_lshl_b32 s65, s59, 7
    s_add_u32 s64, s64, s65
    s_add_u32 s64, s64, 49152
    buffer_load_dwordx4 v245, s[44:47], s64 offen lds
    s_lshl_b32 s64, s62, 14
    s_add_u32 m0, s64, 15360
    s_lshl_b32 s64, s62, 16
    s_lshl_b32 s65, s59, 7
    s_add_u32 s64, s64, s65
    s_add_u32 s64, s64, 57344
    buffer_load_dwordx4 v245, s[44:47], s64 offen lds
    s_cmp_lt_u32 s62, 4
    s_cbranch_scc1 L_h5q
    s_branch L_loop
L_h5q:
    s_branch L_sm
L_h6:
    s_cmp_lt_u32 s62, 4
    s_cbranch_scc1 L_h6q
    s_setprio 1
    s_branch L_sm
L_h6q:
    s_setprio 0
    s_branch L_sm
L_h7:
    s_cmp_lt_u32 s62, 4
    s_cbranch_scc1 L_h7q
    s_setprio 0
    s_branch L_sm
L_h7q:
    s_branch L_sm
L_loop_done:
    v_cvt_pk_bf16_f32 v179, v138, v139
    s_nop 1
    v_mfma_f32_32x32x16_bf16 v[156:171], v[232:235], v[176:179], v[156:171]
    s_mov_b32 s87, 4
    s_mov_b32 s66, 0
L_sm_ret:
    s_waitcnt vmcnt(0)
    s_cmp_ge_u32 s86, s87
    s_cbranch_scc1 L_sm_done
    s_add_u32 s66, s66, 1
    s_cmp_lt_u32 s66, 262144
    s_cbranch_scc1 L_sm
L_sm_done:
    s_cmp_eq_u32 s87, 6
    s_cbranch_scc1 L_sm_done2
    s_lshl_b32 s63, s62, 11
    s_add_u32 s63, s63, 139264
    v_add_u32 v4, s63, v2
    s_lshl_b32 s64, s62, 8
    s_add_u32 s64, s64, 156160
    v_lshrrev_b32 v5, 1, v16
    v_add_u32 v5, s64, v5
    s_cmp_eq_u32 s81, 0
    s_cbranch_scc1 L_ox0
    ds_write_b128 v4, v[140:143]
    ds_write_b128 v4, v[144:147] offset:1024
    ds_write_b32 v5, v148
    v_mov_b32 v124, v156
    v_mov_b32 v125, v157
    v_mov_b32 v126, v158
    v_mov_b32 v127, v159
    v_mov_b32 v128, v160
    v_mov_b32 v129, v161
    v_mov_b32 v130, v162
    v_mov_b32 v131, v163
    v_mov_b32 v132, v164
    v_mov_b32 v180, v184
    v_mov_b32 v181, v185
    v_mov_b32 v182, v186
    v_mov_b32 v183, v187
    s_branch L_ox1
L_ox0:
    ds_write_b128 v4, v[156:159]
    ds_write_b128 v4, v[160:163] offset:1024
    ds_write_b32 v5, v164
    v_mov_b32 v124, v140
    v_mov_b32 v125, v141
    v_mov_b32 v126, v142
    v_mov_b32 v127, v143
    v_mov_b32 v128, v144
    v_mov_b32 v129, v145
    v_mov_b32 v130, v146
    v_mov_b32 v131, v147
    v_mov_b32 v132, v148
L_ox1:
    s_waitcnt lgkmcnt(0)
    s_barrier
    s_xor_b32 s65, s62, 4
    s_lshl_b32 s63, s65, 11
    s_add_u32 s63, s63, 139264
    v_add_u32 v4, s63, v2
    s_lshl_b32 s64, s65, 8
    s_add_u32 s64, s64, 156160
    v_lshrrev_b32 v5, 1, v16
    v_add_u32 v5, s64, v5
    ds_read_b128 v[140:143], v4
    ds_read_b128 v[144:147], v4 offset:1024
    ds_read_b32 v148, v5
    s_waitcnt lgkmcnt(0)
    v_add_f32 v124, v124, v140
    v_add_f32 v125, v125, v141
    v_add_f32 v126, v126, v142
    v_add_f32 v127, v127, v143
    v_add_f32 v128, v128, v144
    v_add_f32 v129, v129, v145
    v_add_f32 v130, v130, v146
    v_add_f32 v131, v131, v147
    v_add_f32 v132, v132, v148
    v_mov_b32 v4, 0x5f800000
    s_mov_b32 s63, 0x207
    v_cmp_nle_f32 vcc, v132, v4
    s_nop 0
    s_mov_b64 s[74:75], vcc
    v_cmp_class_f32 vcc, v124, s63
    s_nop 0
    s_or_b64 s[74:75], s[74:75], vcc
    v_cmp_class_f32 vcc, v125, s63
    s_nop 0
    s_or_b64 s[74:75], s[74:75], vcc
    v_cmp_class_f32 vcc, v126, s63
    s_nop 0
    s_or_b64 s[74:75], s[74:75], vcc
    v_cmp_class_f32 vcc, v127, s63
    s_nop 0
    s_or_b64 s[74:75], s[74:75], vcc
    v_cmp_class_f32 vcc, v128, s63
    s_nop 0
    s_or_b64 s[74:75], s[74:75], vcc
    v_cmp_class_f32 vcc, v129, s63
    s_nop 0
    s_or_b64 s[74:75], s[74:75], vcc
    v_cmp_class_f32 vcc, v130, s63
    s_nop 0
    s_or_b64 s[74:75], s[74:75], vcc
    v_cmp_class_f32 vcc, v131, s63
    s_nop 0
    s_or_b64 s[74:75], s[74:75], vcc
    s_cmp_eq_u64 s[74:75], 0
    s_cbranch_scc1 L_fin
    s_and_b32 s82, s82, 0xffff0000
    s_add_u32 s83, s82, 2097152
    s_mov_b32 s85, 0
    v_mov_b32 v4, 0xff800000
L_fb1:
    s_add_u32 s63, s85, s82
    buffer_load_dwordx4 v[188:191], v2, s[36:39], s63 offen sc1
    s_waitcnt vmcnt(0)
    v_mfma_f32_32x32x16_bf16 v[108:123], v[188:191], v[180:183], 0
    s_nop 11
    v_max3_f32 v4, v4, v108, v109
    v_max3_f32 v4, v4, v110, v111
    v_max3_f32 v4, v4, v112, v113
    v_max3_f32 v4, v4, v114, v115
    v_max3_f32 v4, v4, v116, v117
    v_max3_f32 v4, v4, v118, v119
    v_max3_f32 v4, v4, v120, v121
    v_max3_f32 v4, v4, v122, v123
    s_add_u32 s85, s85, 1024
    s_cmp_lt_u32 s85, 65536
    s_cbranch_scc1 L_fb1
    v_mov_b32 v7, v4
    s_nop 1
    v_permlane32_swap_b32 v4, v7
    v_max_f32 v4, v4, v7
    v_sub_f32 v76, 0, v4
    v_mov_b32 v77, v76
    v_mov_b32 v78, v76
    v_mov_b32 v79, v76
    v_mov_b32 v80, v76
    v_mov_b32 v81, v76
    v_mov_b32 v82, v76
    v_mov_b32 v83, v76
    v_mov_b32 v84, v76
    v_mov_b32 v85, v76
    v_mov_b32 v86, v76
    v_mov_b32 v87, v76
    v_mov_b32 v88, v76
    v_mov_b32 v89, v76
    v_mov_b32 v90, v76
    v_mov_b32 v91, v76
    v_mov_b32 v124, 0
    v_mov_b32 v125, 0
    v_mov_b32 v126, 0
    v_mov_b32 v127, 0
    v_mov_b32 v128, 0
    v_mov_b32 v129, 0
    v_mov_b32 v130, 0
    v_mov_b32 v131, 0
    v_mov_b32 v132, 0
    v_mov_b32 v133, 0
    v_mov_b32 v134, 0
    v_mov_b32 v135, 0
    v_mov_b32 v136, 0
    v_mov_b32 v137, 0
    v_mov_b32 v138, 0
    v_mov_b32 v139, 0
    s_mov_b32 s85, 0
L_fb2:
    s_add_u32 s63, s85, s82
    buffer_load_dwordx4 v[188:191], v2, s[36:39], s63 offen sc1
    s_add_u32 s63, s85, s83
    s_mov_b64 exec, s[26:27]
    buffer_load_dwordx4 v[204:207], v17, s[36:39], s63 offen sc1
    buffer_load_dwordx4 v[220:223], v17, s[36:39], s63 offen offset:512 sc1
    s_mov_b64 exec, -1
    s_waitcnt vmcnt(0)
    v_mfma_f32_32x32x16_bf16 v[108:123], v[188:191], v[180:183], v[76:91]
    s_nop 11
    v_exp_f32 v108, v108
    v_exp_f32 v109, v109
    v_exp_f32 v110, v110
    v_exp_f32 v111, v111
    v_exp_f32 v112, v112
    v_exp_f32 v113, v113
    v_exp_f32 v114, v114
    v_exp_f32 v115, v115
    v_exp_f32 v116, v116
    v_exp_f32 v117, v117
    v_exp_f32 v118, v118
    v_exp_f32 v119, v119
    v_exp_f32 v120, v120
    v_exp_f32 v121, v121
    v_exp_f32 v122, v122
    v_exp_f32 v123, v123
    v_cvt_pk_bf16_f32 v172, v108, v109
    v_cvt_pk_bf16_f32 v173, v110, v111
    v_cvt_pk_bf16_f32 v174, v112, v113
    v_cvt_pk_bf16_f32 v175, v114, v115
    v_cvt_pk_bf16_f32 v176, v116, v117
    v_cvt_pk_bf16_f32 v177, v118, v119
    v_cvt_pk_bf16_f32 v178, v120, v121
    v_cvt_pk_bf16_f32 v179, v122, v123
    v_mfma_f32_32x32x16_bf16 v[124:139], v[204:207], v[172:175], v[124:139]
    s_nop 0
    v_mfma_f32_32x32x16_bf16 v[124:139], v[220:223], v[176:179], v[124:139]
    s_add_u32 s85, s85, 1024
    s_cmp_lt_u32 s85, 65536
    s_cbranch_scc1 L_fb2
L_fin:
    s_nop 8
    v_rcp_f32 v4, v132
    s_nop 0
    v_mul_f32 v124, v124, v4
    v_mul_f32 v125, v125, v4
    v_mul_f32 v126, v126, v4
    v_mul_f32 v127, v127, v4
    v_mul_f32 v128, v128, v4
    v_mul_f32 v129, v129, v4
    v_mul_f32 v130, v130, v4
    v_mul_f32 v131, v131, v4
    v_cvt_pk_bf16_f32 v172, v124, v125
    v_cvt_pk_bf16_f32 v173, v126, v127
    v_cvt_pk_bf16_f32 v174, v128, v129
    v_cvt_pk_bf16_f32 v175, v130, v131
    s_lshl_b32 s63, s61, 1
    s_add_u32 s63, s63, s81
    s_lshl_b32 s63, s63, 5
    s_lshl_b32 s64, s60, 2
    s_add_u32 s63, s63, s64
    s_add_u32 s63, s63, s80
    s_lshl_b32 s63, s63, 10
    s_add_u32 s63, s63, 6291456
    buffer_store_dwordx4 v[172:175], v2, s[36:39], s63 offen sc1
    v_bfe_u32 v9, v1, 2, 2
    v_and_b32 v4, 3, v1
    v_lshlrev_b32 v4, 3, v4
    v_bfe_u32 v10, v1, 4, 1
    v_lshl_add_u32 v4, v10, 5, v4
    v_bfe_u32 v10, v1, 3, 1
    v_lshlrev_b32 v10, 6, v10
    v_xor_b32 v4, v4, v10
    v_lshl_add_u32 v4, v9, 7, v4
    v_lshrrev_b32 v10, 5, v1
    v_lshl_add_u32 v4, v10, 9, v4
    s_lshl_b32 s63, s80, 15
    v_add_u32 v4, s63, v4
    v_xor_b32 v8, 64, v4
    s_cmp_lg_u32 s86, 6
    s_cbranch_scc1 L_lateA
    ds_read_b64_tr_b16 v[76:77], v4 offset:0
    ds_read_b64_tr_b16 v[78:79], v4 offset:1024
    ds_read_b64_tr_b16 v[80:81], v8 offset:0
    ds_read_b64_tr_b16 v[82:83], v8 offset:1024
    ds_read_b64_tr_b16 v[84:85], v4 offset:2048
    ds_read_b64_tr_b16 v[86:87], v4 offset:3072
    ds_read_b64_tr_b16 v[88:89], v8 offset:2048
    ds_read_b64_tr_b16 v[90:91], v8 offset:3072
    s_waitcnt lgkmcnt(4)
    ds_read_b64_tr_b16 v[92:93], v4 offset:4096
    ds_read_b64_tr_b16 v[94:95], v4 offset:5120
    ds_read_b64_tr_b16 v[96:97], v8 offset:4096
    ds_read_b64_tr_b16 v[98:99], v8 offset:5120
    ds_read_b64_tr_b16 v[100:101], v4 offset:6144
    ds_read_b64_tr_b16 v[102:103], v4 offset:7168
    ds_read_b64_tr_b16 v[104:105], v8 offset:6144
    ds_read_b64_tr_b16 v[106:107], v8 offset:7168
    s_waitcnt lgkmcnt(4)
    ds_read_b64_tr_b16 v[108:109], v4 offset:16384
    ds_read_b64_tr_b16 v[110:111], v4 offset:17408
    ds_read_b64_tr_b16 v[112:113], v8 offset:16384
    ds_read_b64_tr_b16 v[114:115], v8 offset:17408
    ds_read_b64_tr_b16 v[116:117], v4 offset:18432
    ds_read_b64_tr_b16 v[118:119], v4 offset:19456
    ds_read_b64_tr_b16 v[120:121], v8 offset:18432
    ds_read_b64_tr_b16 v[122:123], v8 offset:19456
    s_waitcnt lgkmcnt(4)
    ds_read_b64_tr_b16 v[124:125], v4 offset:20480
    ds_read_b64_tr_b16 v[126:127], v4 offset:21504
    ds_read_b64_tr_b16 v[128:129], v8 offset:20480
    ds_read_b64_tr_b16 v[130:131], v8 offset:21504
    ds_read_b64_tr_b16 v[132:133], v4 offset:22528
    ds_read_b64_tr_b16 v[134:135], v4 offset:23552
    ds_read_b64_tr_b16 v[136:137], v8 offset:22528
    ds_read_b64_tr_b16 v[138:139], v8 offset:23552
    s_waitcnt lgkmcnt(0)
    v_mfma_f32_32x32x16_bf16 v[140:155], v[76:79], v[36:39], 0
    v_mfma_f32_32x32x16_bf16 v[156:171], v[80:83], v[36:39], 0
    v_mfma_f32_32x32x16_bf16 v[140:155], v[84:87], v[40:43], v[140:155]
    v_mfma_f32_32x32x16_bf16 v[156:171], v[88:91], v[40:43], v[156:171]
    v_mfma_f32_32x32x16_bf16 v[140:155], v[92:95], v[44:47], v[140:155]
    v_mfma_f32_32x32x16_bf16 v[156:171], v[96:99], v[44:47], v[156:171]
    v_mfma_f32_32x32x16_bf16 v[140:155], v[100:103], v[48:51], v[140:155]
    v_mfma_f32_32x32x16_bf16 v[156:171], v[104:107], v[48:51], v[156:171]
    v_mfma_f32_32x32x16_bf16 v[140:155], v[108:111], v[52:55], v[140:155]
    v_mfma_f32_32x32x16_bf16 v[156:171], v[112:115], v[52:55], v[156:171]
    v_mfma_f32_32x32x16_bf16 v[140:155], v[116:119], v[56:59], v[140:155]
    v_mfma_f32_32x32x16_bf16 v[156:171], v[120:123], v[56:59], v[156:171]
    v_mfma_f32_32x32x16_bf16 v[140:155], v[124:127], v[60:63], v[140:155]
    v_mfma_f32_32x32x16_bf16 v[156:171], v[128:131], v[60:63], v[156:171]
    v_mfma_f32_32x32x16_bf16 v[140:155], v[132:135], v[64:67], v[140:155]
    v_mfma_f32_32x32x16_bf16 v[156:171], v[136:139], v[64:67], v[156:171]
    s_waitcnt vmcnt(0)
    s_lshl_b32 s64, s61, 1
    s_add_u32 s64, s64, s81
    s_lshl_b32 s64, s64, 5
    s_add_u32 s65, s64, s71
    s_lshl_b32 s63, s65, 3
    s_add_u32 s63, s63, 8503296
    s_mov_b64 exec, 1
    buffer_store_dwordx2 v[12:13], v3, s[36:39], s63 offen sc1
    s_mov_b64 exec, -1
    s_branch L_haveA
L_lateA:
    s_mov_b32 s85, 9
    s_branch L_sm
L_sm_x:
    ds_read_b64_tr_b16 v[76:77], v4 offset:0
    ds_read_b64_tr_b16 v[78:79], v4 offset:1024
    ds_read_b64_tr_b16 v[80:81], v8 offset:0
    ds_read_b64_tr_b16 v[82:83], v8 offset:1024
    ds_read_b64_tr_b16 v[84:85], v4 offset:2048
    ds_read_b64_tr_b16 v[86:87], v4 offset:3072
    ds_read_b64_tr_b16 v[88:89], v8 offset:2048
    ds_read_b64_tr_b16 v[90:91], v8 offset:3072
    s_waitcnt lgkmcnt(4)
    ds_read_b64_tr_b16 v[92:93], v4 offset:4096
    ds_read_b64_tr_b16 v[94:95], v4 offset:5120
    ds_read_b64_tr_b16 v[96:97], v8 offset:4096
    ds_read_b64_tr_b16 v[98:99], v8 offset:5120
    ds_read_b64_tr_b16 v[100:101], v4 offset:6144
    ds_read_b64_tr_b16 v[102:103], v4 offset:7168
    ds_read_b64_tr_b16 v[104:105], v8 offset:6144
    ds_read_b64_tr_b16 v[106:107], v8 offset:7168
    s_waitcnt lgkmcnt(4)
    ds_read_b64_tr_b16 v[108:109], v4 offset:16384
    ds_read_b64_tr_b16 v[110:111], v4 offset:17408
    ds_read_b64_tr_b16 v[112:113], v8 offset:16384
    ds_read_b64_tr_b16 v[114:115], v8 offset:17408
    ds_read_b64_tr_b16 v[116:117], v4 offset:18432
    ds_read_b64_tr_b16 v[118:119], v4 offset:19456
    ds_read_b64_tr_b16 v[120:121], v8 offset:18432
    ds_read_b64_tr_b16 v[122:123], v8 offset:19456
    s_waitcnt lgkmcnt(4)
    ds_read_b64_tr_b16 v[124:125], v4 offset:20480
    ds_read_b64_tr_b16 v[126:127], v4 offset:21504
    ds_read_b64_tr_b16 v[128:129], v8 offset:20480
    ds_read_b64_tr_b16 v[130:131], v8 offset:21504
    ds_read_b64_tr_b16 v[132:133], v4 offset:22528
    ds_read_b64_tr_b16 v[134:135], v4 offset:23552
    ds_read_b64_tr_b16 v[136:137], v8 offset:22528
    ds_read_b64_tr_b16 v[138:139], v8 offset:23552
    s_cmp_lg_u32 s86, 6
    s_cbranch_scc1 L_lateA2
    s_waitcnt vmcnt(9)
    s_lshl_b32 s64, s61, 1
    s_add_u32 s64, s64, s81
    s_lshl_b32 s64, s64, 5
    s_add_u32 s65, s64, s71
    s_lshl_b32 s63, s65, 3
    s_add_u32 s63, s63, 8503296
    s_mov_b64 exec, 1
    buffer_store_dwordx2 v[12:13], v3, s[36:39], s63 offen sc1
    s_mov_b64 exec, -1
    s_waitcnt vmcnt(1) lgkmcnt(0)
    v_mfma_f32_32x32x16_bf16 v[140:155], v[76:79], v[36:39], 0
    v_mfma_f32_32x32x16_bf16 v[156:171], v[80:83], v[36:39], 0
    v_mfma_f32_32x32x16_bf16 v[140:155], v[84:87], v[40:43], v[140:155]
    v_mfma_f32_32x32x16_bf16 v[156:171], v[88:91], v[40:43], v[156:171]
    v_mfma_f32_32x32x16_bf16 v[140:155], v[92:95], v[44:47], v[140:155]
    v_mfma_f32_32x32x16_bf16 v[156:171], v[96:99], v[44:47], v[156:171]
    v_mfma_f32_32x32x16_bf16 v[140:155], v[100:103], v[48:51], v[140:155]
    v_mfma_f32_32x32x16_bf16 v[156:171], v[104:107], v[48:51], v[156:171]
    v_mfma_f32_32x32x16_bf16 v[140:155], v[108:111], v[52:55], v[140:155]
    v_mfma_f32_32x32x16_bf16 v[156:171], v[112:115], v[52:55], v[156:171]
    v_mfma_f32_32x32x16_bf16 v[140:155], v[116:119], v[56:59], v[140:155]
    v_mfma_f32_32x32x16_bf16 v[156:171], v[120:123], v[56:59], v[156:171]
    v_mfma_f32_32x32x16_bf16 v[140:155], v[124:127], v[60:63], v[140:155]
    v_mfma_f32_32x32x16_bf16 v[156:171], v[128:131], v[60:63], v[156:171]
    v_mfma_f32_32x32x16_bf16 v[140:155], v[132:135], v[64:67], v[140:155]
    v_mfma_f32_32x32x16_bf16 v[156:171], v[136:139], v[64:67], v[156:171]
    s_branch L_haveA
L_lateA2:
    s_waitcnt vmcnt(0) lgkmcnt(0)
    s_lshl_b32 s64, s61, 1
    s_add_u32 s64, s64, s81
    s_lshl_b32 s64, s64, 5
    s_add_u32 s65, s64, s71
    s_lshl_b32 s63, s65, 3
    s_add_u32 s63, s63, 8503296
    s_mov_b64 exec, 1
    buffer_store_dwordx2 v[12:13], v3, s[36:39], s63 offen sc1
    s_mov_b64 exec, -1
    s_mov_b32 s85, 8
    s_mov_b32 s87, 6
    s_mov_b32 s66, 0
    s_branch L_sm_ret
L_sm_done2:
    v_mfma_f32_32x32x16_bf16 v[140:155], v[76:79], v[36:39], 0
    s_nop 1
    v_mfma_f32_32x32x16_bf16 v[156:171], v[80:83], v[36:39], 0
    v_mfma_f32_32x32x16_bf16 v[140:155], v[84:87], v[40:43], v[140:155]
    v_mfma_f32_32x32x16_bf16 v[156:171], v[88:91], v[40:43], v[156:171]
    v_mfma_f32_32x32x16_bf16 v[140:155], v[92:95], v[44:47], v[140:155]
    v_mfma_f32_32x32x16_bf16 v[156:171], v[96:99], v[44:47], v[156:171]
    v_mfma_f32_32x32x16_bf16 v[140:155], v[100:103], v[48:51], v[140:155]
    v_mfma_f32_32x32x16_bf16 v[156:171], v[104:107], v[48:51], v[156:171]
    v_mfma_f32_32x32x16_bf16 v[140:155], v[108:111], v[52:55], v[140:155]
    v_mfma_f32_32x32x16_bf16 v[156:171], v[112:115], v[52:55], v[156:171]
    v_mfma_f32_32x32x16_bf16 v[140:155], v[116:119], v[56:59], v[140:155]
    v_mfma_f32_32x32x16_bf16 v[156:171], v[120:123], v[56:59], v[156:171]
    v_mfma_f32_32x32x16_bf16 v[140:155], v[124:127], v[60:63], v[140:155]
    v_mfma_f32_32x32x16_bf16 v[156:171], v[128:131], v[60:63], v[156:171]
    v_mfma_f32_32x32x16_bf16 v[140:155], v[132:135], v[64:67], v[140:155]
    v_mfma_f32_32x32x16_bf16 v[156:171], v[136:139], v[64:67], v[156:171]
L_haveA:
    v_and_b32 v244, 56, v16
    s_lshl_b32 s64, s3, 1
    s_add_u32 s64, s64, s81
    s_lshl_b32 s73, s64, 8
    s_lshl_b32 s63, s80, 6
    s_add_u32 s73, s73, s63
    s_add_u32 s73, s73, 8503296
    buffer_load_dwordx2 v[14:15], v244, s[36:39], s73 offen sc1
    ds_read_b64_tr_b16 v[76:77], v4 offset:8192
    ds_read_b64_tr_b16 v[78:79], v4 offset:9216
    ds_read_b64_tr_b16 v[80:81], v8 offset:8192
    ds_read_b64_tr_b16 v[82:83], v8 offset:9216
    ds_read_b64_tr_b16 v[84:85], v4 offset:10240
    ds_read_b64_tr_b16 v[86:87], v4 offset:11264
    ds_read_b64_tr_b16 v[88:89], v8 offset:10240
    ds_read_b64_tr_b16 v[90:91], v8 offset:11264
    s_waitcnt lgkmcnt(4)
    ds_read_b64_tr_b16 v[92:93], v4 offset:12288
    ds_read_b64_tr_b16 v[94:95], v4 offset:13312
    ds_read_b64_tr_b16 v[96:97], v8 offset:12288
    ds_read_b64_tr_b16 v[98:99], v8 offset:13312
    ds_read_b64_tr_b16 v[100:101], v4 offset:14336
    ds_read_b64_tr_b16 v[102:103], v4 offset:15360
    ds_read_b64_tr_b16 v[104:105], v8 offset:14336
    ds_read_b64_tr_b16 v[106:107], v8 offset:15360
    s_waitcnt lgkmcnt(4)
    ds_read_b64_tr_b16 v[108:109], v4 offset:24576
    ds_read_b64_tr_b16 v[110:111], v4 offset:25600
    ds_read_b64_tr_b16 v[112:113], v8 offset:24576
    ds_read_b64_tr_b16 v[114:115], v8 offset:25600
    ds_read_b64_tr_b16 v[116:117], v4 offset:26624
    ds_read_b64_tr_b16 v[118:119], v4 offset:27648
    ds_read_b64_tr_b16 v[120:121], v8 offset:26624
    ds_read_b64_tr_b16 v[122:123], v8 offset:27648
    s_waitcnt lgkmcnt(4)
    ds_read_b64_tr_b16 v[124:125], v4 offset:28672
    ds_read_b64_tr_b16 v[126:127], v4 offset:29696
    ds_read_b64_tr_b16 v[128:129], v8 offset:28672
    ds_read_b64_tr_b16 v[130:131], v8 offset:29696
    ds_read_b64_tr_b16 v[132:133], v4 offset:30720
    ds_read_b64_tr_b16 v[134:135], v4 offset:31744
    ds_read_b64_tr_b16 v[136:137], v8 offset:30720
    ds_read_b64_tr_b16 v[138:139], v8 offset:31744
    v_sub_f32 v69, 1.0, v68
    v_cvt_pk_bf16_f32 v69, v69, v69
    v_and_b32 v69, 0xffff0000, v69
    v_mul_f32 v140, v140, v68
    v_mul_f32 v141, v141, v68
    v_mul_f32 v142, v142, v68
    v_mul_f32 v143, v143, v68
    v_mul_f32 v144, v144, v68
    v_mul_f32 v145, v145, v68
    v_mul_f32 v146, v146, v68
    v_mul_f32 v147, v147, v68
    v_mul_f32 v148, v148, v68
    v_mul_f32 v149, v149, v68
    v_mul_f32 v150, v150, v68
    v_mul_f32 v151, v151, v68
    v_mul_f32 v152, v152, v68
    v_mul_f32 v153, v153, v68
    v_mul_f32 v154, v154, v68
    v_mul_f32 v155, v155, v68
    v_mul_f32 v156, v156, v68
    v_mul_f32 v157, v157, v68
    v_mul_f32 v158, v158, v68
    v_mul_f32 v159, v159, v68
    v_mul_f32 v160, v160, v68
    v_mul_f32 v161, v161, v68
    v_mul_f32 v162, v162, v68
    v_mul_f32 v163, v163, v68
    v_mul_f32 v164, v164, v68
    v_mul_f32 v165, v165, v68
    v_mul_f32 v166, v166, v68
    v_mul_f32 v167, v167, v68
    v_mul_f32 v168, v168, v68
    v_mul_f32 v169, v169, v68
    v_mul_f32 v170, v170, v68
    v_mul_f32 v171, v171, v68
    v_and_b32 v5, 31, v1
    v_mul_u32_u24 v5, 272, v5
    v_lshrrev_b32 v6, 5, v1
    v_lshl_add_u32 v5, v6, 4, v5
    s_mul_i32 s65, s80, 17408
    s_mul_i32 s66, s81, 8704
    s_add_u32 s65, s65, s66
    v_add_u32 v5, s65, v5
    s_waitcnt lgkmcnt(0)
    s_barrier
    s_mov_b32 s66, 0
L_sp4:
    s_waitcnt vmcnt(0)
    v_cmp_eq_u64 vcc, v[14:15], v[12:13]
    s_nop 0
    s_cmp_eq_u64 vcc, -1
    s_cbranch_scc1 L_sp4_ok
    s_sleep 4
    buffer_load_dwordx2 v[14:15], v244, s[36:39], s73 offen sc1
    s_add_u32 s66, s66, 1
    s_cmp_lt_u32 s66, 262144
    s_cbranch_scc1 L_sp4
L_sp4_ok:
    s_lshl_b32 s63, s3, 16
    s_lshl_b32 s64, s81, 15
    s_add_u32 s63, s63, s64
    s_lshl_b32 s64, s80, 13
    s_add_u32 s63, s63, s64
    s_add_u32 s63, s63, 6291456
    s_add_u32 s64, s63, 4096
    buffer_load_dwordx4 v[204:207], v2, s[36:39], s63 offen offset:0 sc1
    buffer_load_dwordx4 v[208:211], v2, s[36:39], s63 offen offset:1024 sc1
    buffer_load_dwordx4 v[212:215], v2, s[36:39], s63 offen offset:2048 sc1
    buffer_load_dwordx4 v[216:219], v2, s[36:39], s63 offen offset:3072 sc1
    buffer_load_dwordx4 v[220:223], v2, s[36:39], s64 offen offset:0 sc1
    buffer_load_dwordx4 v[224:227], v2, s[36:39], s64 offen offset:1024 sc1
    buffer_load_dwordx4 v[228:231], v2, s[36:39], s64 offen offset:2048 sc1
    buffer_load_dwordx4 v[232:235], v2, s[36:39], s64 offen offset:3072 sc1
    s_waitcnt vmcnt(7)
    v_mfma_f32_32x32x16_bf16 v[172:187], v[76:79], v[204:207], 0
    v_mfma_f32_32x32x16_bf16 v[188:203], v[80:83], v[204:207], 0
    s_waitcnt vmcnt(6)
    v_mfma_f32_32x32x16_bf16 v[172:187], v[84:87], v[208:211], v[172:187]
    v_mfma_f32_32x32x16_bf16 v[188:203], v[88:91], v[208:211], v[188:203]
    s_waitcnt vmcnt(5)
    v_mfma_f32_32x32x16_bf16 v[172:187], v[92:95], v[212:215], v[172:187]
    v_mfma_f32_32x32x16_bf16 v[188:203], v[96:99], v[212:215], v[188:203]
    s_waitcnt vmcnt(4)
    v_mfma_f32_32x32x16_bf16 v[172:187], v[100:103], v[216:219], v[172:187]
    v_mfma_f32_32x32x16_bf16 v[188:203], v[104:107], v[216:219], v[188:203]
    s_waitcnt vmcnt(3)
    v_mfma_f32_32x32x16_bf16 v[172:187], v[108:111], v[220:223], v[172:187]
    v_mfma_f32_32x32x16_bf16 v[188:203], v[112:115], v[220:223], v[188:203]
    s_waitcnt vmcnt(2)
    v_mfma_f32_32x32x16_bf16 v[172:187], v[116:119], v[224:227], v[172:187]
    v_mfma_f32_32x32x16_bf16 v[188:203], v[120:123], v[224:227], v[188:203]
    s_waitcnt vmcnt(1)
    v_mfma_f32_32x32x16_bf16 v[172:187], v[124:127], v[228:231], v[172:187]
    v_mfma_f32_32x32x16_bf16 v[188:203], v[128:131], v[228:231], v[188:203]
    s_waitcnt vmcnt(0)
    v_mfma_f32_32x32x16_bf16 v[172:187], v[132:135], v[232:235], v[172:187]
    v_mfma_f32_32x32x16_bf16 v[188:203], v[136:139], v[232:235], v[188:203]
    s_nop 10
    v_fmac_f32 v140, v172, v69
    v_fmac_f32 v141, v173, v69
    v_fmac_f32 v142, v174, v69
    v_fmac_f32 v143, v175, v69
    v_fmac_f32 v144, v176, v69
    v_fmac_f32 v145, v177, v69
    v_fmac_f32 v146, v178, v69
    v_fmac_f32 v147, v179, v69
    v_fmac_f32 v148, v180, v69
    v_fmac_f32 v149, v181, v69
    v_fmac_f32 v150, v182, v69
    v_fmac_f32 v151, v183, v69
    v_fmac_f32 v152, v184, v69
    v_fmac_f32 v153, v185, v69
    v_fmac_f32 v154, v186, v69
    v_fmac_f32 v155, v187, v69
    ds_write_b128 v5, v[140:143] offset:0
    ds_write_b128 v5, v[144:147] offset:32
    ds_write_b128 v5, v[148:151] offset:64
    ds_write_b128 v5, v[152:155] offset:96
    v_fmac_f32 v156, v188, v69
    v_fmac_f32 v157, v189, v69
    v_fmac_f32 v158, v190, v69
    v_fmac_f32 v159, v191, v69
    v_fmac_f32 v160, v192, v69
    v_fmac_f32 v161, v193, v69
    v_fmac_f32 v162, v194, v69
    v_fmac_f32 v163, v195, v69
    v_fmac_f32 v164, v196, v69
    v_fmac_f32 v165, v197, v69
    v_fmac_f32 v166, v198, v69
    v_fmac_f32 v167, v199, v69
    v_fmac_f32 v168, v200, v69
    v_fmac_f32 v169, v201, v69
    v_fmac_f32 v170, v202, v69
    v_fmac_f32 v171, v203, v69
    ds_write_b128 v5, v[156:159] offset:128
    ds_write_b128 v5, v[160:163] offset:160
    ds_write_b128 v5, v[164:167] offset:192
    ds_write_b128 v5, v[168:171] offset:224
    s_waitcnt lgkmcnt(0)
    s_barrier
    v_lshrrev_b32 v4, 3, v0
    v_and_b32 v5, 7, v0
    v_mul_u32_u24 v6, 272, v4
    v_lshl_add_u32 v6, v5, 5, v6
    ds_read_b128 v[76:79], v6 offset:0
    ds_read_b128 v[80:83], v6 offset:16
    ds_read_b128 v[84:87], v6 offset:17408
    ds_read_b128 v[88:91], v6 offset:17424
    ds_read_b128 v[92:95], v6 offset:34816
    ds_read_b128 v[96:99], v6 offset:34832
    ds_read_b128 v[100:103], v6 offset:52224
    ds_read_b128 v[104:107], v6 offset:52240
    v_lshlrev_b32 v7, 10, v4
    v_lshl_add_u32 v7, v5, 4, v7
    s_lshl_b32 s65, s3, 16
    s_lshl_b32 s66, s59, 7
    s_add_u32 s65, s65, s66
    s_waitcnt lgkmcnt(4)
    v_pk_add_f32 v[76:77], v[76:77], v[84:85]
    v_pk_add_f32 v[78:79], v[78:79], v[86:87]
    v_pk_add_f32 v[80:81], v[80:81], v[88:89]
    v_pk_add_f32 v[82:83], v[82:83], v[90:91]
    s_waitcnt lgkmcnt(0)
    v_pk_add_f32 v[92:93], v[92:93], v[100:101]
    v_pk_add_f32 v[94:95], v[94:95], v[102:103]
    v_pk_add_f32 v[96:97], v[96:97], v[104:105]
    v_pk_add_f32 v[98:99], v[98:99], v[106:107]
    v_pk_add_f32 v[76:77], v[76:77], v[92:93]
    v_pk_add_f32 v[78:79], v[78:79], v[94:95]
    v_pk_add_f32 v[80:81], v[80:81], v[96:97]
    v_pk_add_f32 v[82:83], v[82:83], v[98:99]
    v_cvt_pk_bf16_f32 v108, v76, v77
    v_cvt_pk_bf16_f32 v109, v78, v79
    v_cvt_pk_bf16_f32 v110, v80, v81
    v_cvt_pk_bf16_f32 v111, v82, v83
    buffer_store_dwordx4 v[108:111], v7, s[52:55], s65 offen sc1
L_end:
    s_endpgm
.section .rodata,"a"
.p2align 6
.amdhsa_kernel gated_mix__linear_kernel_hedgehog__softmax_full_mha__prompt_kernel
  .amdhsa_next_free_vgpr 254
  .amdhsa_next_free_sgpr 88
  .amdhsa_accum_offset 256
  .amdhsa_group_segment_fixed_size 0
  .amdhsa_kernarg_size 88
  .amdhsa_user_sgpr_count 2
  .amdhsa_user_sgpr_kernarg_segment_ptr 1
  .amdhsa_system_sgpr_workgroup_id_x 1
.end_amdhsa_kernel
.text
```
